```python
import torch

def _softmax(x, axis=-1):
    return torch.softmax(x, dim=axis)

def _gelu(x):
    return torch.nn.functional.gelu(x, approximate='tanh')

def _silu(x):
    return torch.nn.functional.silu(x)

def _sigmoid(x):
    return torch.sigmoid(x)

def _layernorm(x, axis=-1, eps=1e-05):
    m = x.mean(dim=axis, keepdim=True)
    v = x.var(dim=axis, keepdim=True, unbiased=False)
    return (x - m) / torch.sqrt(v + eps)

def _scatter_add(tgt, idx, src, axis=0):
    return tgt.clone().index_add_(axis, idx, src)

def _segment_sum(src, seg, n):
    out = torch.zeros((n,) + src.shape[1:], dtype=src.dtype)
    return out.index_add_(0, seg, src)

def _pad(x, pw):
    flat = tuple((v for pair in reversed(pw) for v in pair))
    return torch.nn.functional.pad(x, flat)
kernel_name = 'standalone__dit_adaln_block__diffusion'

def setup_inputs():

    _w = lambda a: (lambda t: t.to(torch.bfloat16) if t.is_floating_point() else t)(torch.as_tensor(a))
    B, N, D = (2, 1024, 768)
    return {'x': _w((lambda *s: torch.randn(*s, dtype=torch.bfloat16) * 0.05)(B, N, D)), 'c': _w((lambda *s: torch.randn(*s, dtype=torch.bfloat16) * 0.2)(B, D)), 'wqkv': _w((lambda *s: torch.randn(*s, dtype=torch.bfloat16) * 0.05)(D, 3 * D)), 'wo': _w((lambda *s: torch.randn(*s, dtype=torch.bfloat16) * 0.05)(D, D)), 'w_mod': _w((lambda *s: torch.randn(*s, dtype=torch.bfloat16) * 0.2)(D, 6 * D))}

def reference(x, c, wqkv, wo, w_mod):
    B, N, D = x.shape
    mod = (_silu(c) @ w_mod).reshape(B, 6, 1, D)
    shift_a, scale_a, gate_a, shift_m, scale_m, gate_m = [mod[:, i] for i in range(6)]
    h = _layernorm(x, axis=-1) * (1 + scale_a) + shift_a
    qkv = h @ wqkv
    q, k, v = (qkv[..., :D].clone(), qkv[..., D:2 * D].clone(), qkv[..., 2 * D:].clone())
    p = _softmax(torch.einsum('bqd,bkd->bqk', q, k) * D ** (-0.5), axis=-1)
    a = torch.einsum('bqk,bkd->bqd', p, v) @ wo
    return x + gate_a * a
```

```asm
; @launch grid=(256,1,1) block=(256,1,1) lds=163840
.amdgcn_target "amdgcn-amd-amdhsa--gfx950"
.text
.globl standalone__dit_adaln_block__diffusion_kernel
.p2align 8
.type standalone__dit_adaln_block__diffusion_kernel,@function
standalone__dit_adaln_block__diffusion_kernel:
    s_cmp_ge_u32 s2, 256
    s_cbranch_scc1 L_end
    s_load_dwordx16 s[4:19], s[0:1], 0
    s_memrealtime s[86:87]
    s_getpc_b64 s[96:97]
L_pc:
    v_lshrrev_b32 v4, 6, v0
    v_and_b32 v0, 63, v0
    v_readfirstlane_b32 s3, v4
    v_lshlrev_b32 v1, 4, v0
    s_sub_u32 s96, s96, L_pc-standalone__dit_adaln_block__diffusion_kernel
    s_subb_u32 s97, s97, 0
    s_mov_b32 s98, L_codeend-standalone__dit_adaln_block__diffusion_kernel
    s_mov_b32 s99, 0x20000
    s_and_b32 s52, s2, 7
    s_lshr_b32 s53, s2, 3
    s_mov_b32 s91, 0xffff0000
    s_lshl_b32 s56, s53, 2
    s_add_u32 s56, s56, s3
    s_lshl_b32 s56, s56, 10
    v_add_u32 v60, s56, v1
    buffer_load_dwordx4 v[60:63], v60, s[96:99], 0 offen
    s_waitcnt lgkmcnt(0)
    s_mov_b32 s20, s4
    s_mov_b32 s21, s5
    s_mov_b32 s22, 3145728
    s_mov_b32 s23, 0x20000
    s_mov_b32 s48, s18
    s_mov_b32 s49, s19
    s_mov_b32 s50, 20971520
    s_mov_b32 s51, 0x20000
    s_mov_b32 s44, s16
    s_mov_b32 s45, s17
    s_mov_b32 s46, 256
    s_mov_b32 s47, 0x20000
    s_mov_b32 s40, s14
    s_mov_b32 s41, s15
    s_mov_b32 s42, 3145728
    s_mov_b32 s43, 0x20000
    s_or_b32 s57, s2, s3
    s_cmp_eq_u32 s57, 0
    s_cbranch_scc0 L_nn_1
    s_or_b32 s57, s86, 1
    v_mov_b32 v2, s57
    v_mov_b32 v3, s87
    s_mov_b64 exec, 1
    buffer_store_dwordx2 v[2:3], off, s[44:47], 0 sc1
    s_mov_b64 exec, -1
L_nn_1:
    s_cmp_lt_u32 s53, 24
    s_cbranch_scc1 L_A_gemm
    s_xor_b32 s64, s52, 2
    s_lshl_b32 s64, s64, 3
    s_add_u32 s64, s64, s53
    s_sub_u32 s64, s64, 24
    s_cmp_lt_u32 s53, 30
    s_cbranch_scc1 L_A_mod
    buffer_load_dwordx2 v[2:3], off, s[44:47], 0 sc1
    s_lshl_b32 s69, s64, 2
    s_add_u32 s69, s69, s3
    s_mul_i32 s69, s69, 12288
    v_lshlrev_b32 v4, 3, v0
    buffer_load_dwordx2 v[64:65], v4, s[20:23], s69 offen offset:0 nt
    buffer_load_dwordx2 v[66:67], v4, s[20:23], s69 offen offset:512 nt
    buffer_load_dwordx2 v[68:69], v4, s[20:23], s69 offen offset:1024 nt
    buffer_load_dwordx2 v[70:71], v4, s[20:23], s69 offen offset:1536 nt
    buffer_load_dwordx2 v[72:73], v4, s[20:23], s69 offen offset:2048 nt
    buffer_load_dwordx2 v[74:75], v4, s[20:23], s69 offen offset:2560 nt
    s_add_u32 s69, s69, 3072
    buffer_load_dwordx2 v[76:77], v4, s[20:23], s69 offen offset:0 nt
    buffer_load_dwordx2 v[78:79], v4, s[20:23], s69 offen offset:512 nt
    buffer_load_dwordx2 v[80:81], v4, s[20:23], s69 offen offset:1024 nt
    buffer_load_dwordx2 v[82:83], v4, s[20:23], s69 offen offset:1536 nt
    buffer_load_dwordx2 v[84:85], v4, s[20:23], s69 offen offset:2048 nt
    buffer_load_dwordx2 v[86:87], v4, s[20:23], s69 offen offset:2560 nt
    s_add_u32 s69, s69, 3072
    buffer_load_dwordx2 v[88:89], v4, s[20:23], s69 offen offset:0 nt
    buffer_load_dwordx2 v[90:91], v4, s[20:23], s69 offen offset:512 nt
    buffer_load_dwordx2 v[92:93], v4, s[20:23], s69 offen offset:1024 nt
    buffer_load_dwordx2 v[94:95], v4, s[20:23], s69 offen offset:1536 nt
    buffer_load_dwordx2 v[96:97], v4, s[20:23], s69 offen offset:2048 nt
    buffer_load_dwordx2 v[98:99], v4, s[20:23], s69 offen offset:2560 nt
    s_add_u32 s69, s69, 3072
    buffer_load_dwordx2 v[100:101], v4, s[20:23], s69 offen offset:0 nt
    buffer_load_dwordx2 v[102:103], v4, s[20:23], s69 offen offset:512 nt
    buffer_load_dwordx2 v[104:105], v4, s[20:23], s69 offen offset:1024 nt
    buffer_load_dwordx2 v[106:107], v4, s[20:23], s69 offen offset:1536 nt
    buffer_load_dwordx2 v[108:109], v4, s[20:23], s69 offen offset:2048 nt
    buffer_load_dwordx2 v[110:111], v4, s[20:23], s69 offen offset:2560 nt
    s_lshr_b32 s57, s52, 1
    s_lshl_b32 s57, s57, 2
    s_and_b32 s58, s53, 3
    s_add_u32 s54, s57, s58
    s_and_b32 s57, s52, 1
    s_lshl_b32 s57, s57, 3
    s_lshr_b32 s58, s53, 2
    s_add_u32 s55, s57, s58
    s_branch L_A_ln
L_A_mod:
    s_mov_b32 s24, s6
    s_mov_b32 s25, s7
    s_mov_b32 s26, 3072
    s_mov_b32 s27, 0x20000
    s_mov_b32 s36, s12
    s_mov_b32 s37, s13
    s_mov_b32 s38, 7077888
    s_mov_b32 s39, 0x20000
    s_mul_i32 s68, s52, 6
    s_add_u32 s68, s68, s53
    s_sub_u32 s68, s68, 24
    s_lshr_b32 s65, s68, 1
    s_and_b32 s66, s68, 1
    s_mul_i32 s57, s66, 384
    s_mul_i32 s58, s3, 96
    s_add_u32 s57, s57, s58
    s_lshl_b32 s58, s57, 1
    v_lshl_add_u32 v12, v0, 2, s58
    buffer_load_dword v6, v12, s[24:27], 0 offen offset:0
    buffer_load_dword v7, v12, s[24:27], 0 offen offset:1536
    v_lshrrev_b32 v13, 3, v0
    v_mul_u32_u24 v14, 9216, v13
    v_and_b32 v15, 7, v0
    v_lshl_add_u32 v14, v15, 4, v14
    s_mul_i32 s67, s57, 9216
    s_lshl_b32 s58, s65, 7
    s_add_u32 s67, s67, s58
    s_mul_i32 s93, s3, 12288
    s_add_u32 m0, s93, 0
    s_nop 0
    buffer_load_dwordx4 v14, s[36:39], s67 offen nt lds
    s_add_u32 s67, s67, 73728
    s_add_u32 m0, s93, 1024
    s_nop 0
    buffer_load_dwordx4 v14, s[36:39], s67 offen nt lds
    s_add_u32 s67, s67, 73728
    s_add_u32 m0, s93, 2048
    s_nop 0
    buffer_load_dwordx4 v14, s[36:39], s67 offen nt lds
    s_add_u32 s67, s67, 73728
    s_add_u32 m0, s93, 3072
    s_nop 0
    buffer_load_dwordx4 v14, s[36:39], s67 offen nt lds
    s_add_u32 s67, s67, 73728
    s_add_u32 m0, s93, 4096
    s_nop 0
    buffer_load_dwordx4 v14, s[36:39], s67 offen nt lds
    s_add_u32 s67, s67, 73728
    s_add_u32 m0, s93, 5120
    s_nop 0
    buffer_load_dwordx4 v14, s[36:39], s67 offen nt lds
    s_add_u32 s67, s67, 73728
    s_add_u32 m0, s93, 6144
    s_nop 0
    buffer_load_dwordx4 v14, s[36:39], s67 offen nt lds
    s_add_u32 s67, s67, 73728
    s_add_u32 m0, s93, 7168
    s_nop 0
    buffer_load_dwordx4 v14, s[36:39], s67 offen nt lds
    s_add_u32 s67, s67, 73728
    s_add_u32 m0, s93, 8192
    s_nop 0
    buffer_load_dwordx4 v14, s[36:39], s67 offen nt lds
    s_add_u32 s67, s67, 73728
    s_add_u32 m0, s93, 9216
    s_nop 0
    buffer_load_dwordx4 v14, s[36:39], s67 offen nt lds
    s_add_u32 s67, s67, 73728
    s_add_u32 m0, s93, 10240
    s_nop 0
    buffer_load_dwordx4 v14, s[36:39], s67 offen nt lds
    s_add_u32 s67, s67, 73728
    s_add_u32 m0, s93, 11264
    s_nop 0
    buffer_load_dwordx4 v14, s[36:39], s67 offen nt lds
    s_lshr_b32 s57, s52, 1
    s_lshl_b32 s57, s57, 2
    s_and_b32 s58, s53, 3
    s_add_u32 s54, s57, s58
    s_and_b32 s57, s52, 1
    s_lshl_b32 s57, s57, 3
    s_lshr_b32 s58, s53, 2
    s_add_u32 s55, s57, s58
    s_waitcnt vmcnt(12)
    v_lshlrev_b32 v16, 16, v6
    v_and_b32 v17, s91, v6
    v_lshlrev_b32 v18, 16, v7
    v_and_b32 v19, s91, v7
    s_mov_b32 s57, 0xbfb8aa3b
    v_mul_f32 v32, s57, v16
    v_mul_f32 v33, s57, v17
    v_mul_f32 v34, s57, v18
    v_mul_f32 v35, s57, v19
    v_exp_f32 v32, v32
    v_exp_f32 v33, v33
    v_exp_f32 v34, v34
    v_exp_f32 v35, v35
    v_add_f32 v32, 1.0, v32
    v_add_f32 v33, 1.0, v33
    v_add_f32 v34, 1.0, v34
    v_add_f32 v35, 1.0, v35
    v_rcp_f32 v32, v32
    v_rcp_f32 v33, v33
    v_rcp_f32 v34, v34
    v_rcp_f32 v35, v35
    v_mul_f32 v16, v16, v32
    v_mul_f32 v17, v17, v33
    v_mul_f32 v18, v18, v34
    v_mul_f32 v19, v19, v35
    v_cvt_pk_bf16_f32 v40, v16, v17
    v_cvt_pk_bf16_f32 v41, v18, v19
    v_lshlrev_b32 v32, 16, v40
    v_and_b32 v33, s91, v40
    v_lshlrev_b32 v34, 16, v41
    v_and_b32 v35, s91, v41
    v_sub_f32 v16, v16, v32
    v_sub_f32 v17, v17, v33
    v_sub_f32 v18, v18, v34
    v_sub_f32 v19, v19, v35
    v_cvt_pk_bf16_f32 v44, v16, v17
    v_cvt_pk_bf16_f32 v45, v18, v19
    s_lshl_b32 s57, s3, 11
    s_add_u32 s57, s57, 147456
    v_lshl_add_u32 v12, v0, 2, s57
    s_bfm_b64 exec, 48, 0
    ds_write_b32 v12, v40 offset:0
    ds_write_b32 v12, v44 offset:384
    ds_write_b32 v12, v41 offset:192
    ds_write_b32 v12, v45 offset:576
    s_mov_b64 exec, -1
    v_and_b32 v12, 3, v0
    v_mul_u32_u24 v12, 192, v12
    v_lshrrev_b32 v16, 5, v0
    v_lshl_add_u32 v12, v16, 4, v12
    v_add_u32 v12, s57, v12
    v_lshrrev_b32 v13, 2, v0
    v_and_b32 v13, 3, v13
    v_lshl_add_u32 v13, v16, 3, v13
    v_lshlrev_b32 v13, 7, v13
    v_lshrrev_b32 v16, 4, v0
    v_and_b32 v16, 1, v16
    v_lshl_add_u32 v13, v16, 5, v13
    v_and_b32 v16, 3, v0
    v_lshl_add_u32 v13, v16, 3, v13
    s_mul_i32 s57, s3, 12288
    v_add_u32 v13, s57, v13
    buffer_load_dwordx2 v[2:3], off, s[44:47], 0 sc1
    s_lshl_b32 s69, s64, 2
    s_add_u32 s69, s69, s3
    s_mul_i32 s69, s69, 12288
    v_lshlrev_b32 v4, 3, v0
    buffer_load_dwordx2 v[64:65], v4, s[20:23], s69 offen offset:0 nt
    buffer_load_dwordx2 v[66:67], v4, s[20:23], s69 offen offset:512 nt
    buffer_load_dwordx2 v[68:69], v4, s[20:23], s69 offen offset:1024 nt
    buffer_load_dwordx2 v[70:71], v4, s[20:23], s69 offen offset:1536 nt
    buffer_load_dwordx2 v[72:73], v4, s[20:23], s69 offen offset:2048 nt
    buffer_load_dwordx2 v[74:75], v4, s[20:23], s69 offen offset:2560 nt
    s_add_u32 s69, s69, 3072
    buffer_load_dwordx2 v[76:77], v4, s[20:23], s69 offen offset:0 nt
    buffer_load_dwordx2 v[78:79], v4, s[20:23], s69 offen offset:512 nt
    buffer_load_dwordx2 v[80:81], v4, s[20:23], s69 offen offset:1024 nt
    buffer_load_dwordx2 v[82:83], v4, s[20:23], s69 offen offset:1536 nt
    buffer_load_dwordx2 v[84:85], v4, s[20:23], s69 offen offset:2048 nt
    buffer_load_dwordx2 v[86:87], v4, s[20:23], s69 offen offset:2560 nt
    s_waitcnt lgkmcnt(0)
    ds_read_b128 a[0:3], v12 offset:0
    ds_read_b128 a[4:7], v12 offset:32
    ds_read_b128 a[8:11], v12 offset:64
    ds_read_b128 a[12:15], v12 offset:96
    ds_read_b128 a[16:19], v12 offset:128
    ds_read_b128 a[20:23], v12 offset:160
    s_waitcnt vmcnt(13)
    ds_read_b64_tr_b16 a[48:49], v13 offset:0
    ds_read_b64_tr_b16 a[50:51], v13 offset:512
    ds_read_b64_tr_b16 a[52:53], v13 offset:64
    ds_read_b64_tr_b16 a[54:55], v13 offset:576
    ds_read_b64_tr_b16 a[56:57], v13 offset:2048
    ds_read_b64_tr_b16 a[58:59], v13 offset:2560
    ds_read_b64_tr_b16 a[60:61], v13 offset:2112
    ds_read_b64_tr_b16 a[62:63], v13 offset:2624
    ds_read_b64_tr_b16 a[64:65], v13 offset:4096
    ds_read_b64_tr_b16 a[66:67], v13 offset:4608
    ds_read_b64_tr_b16 a[68:69], v13 offset:4160
    ds_read_b64_tr_b16 a[70:71], v13 offset:4672
    s_waitcnt lgkmcnt(8)
    v_mfma_f32_32x32x16_bf16 v[16:31], a[0:3], a[48:51], 0
    v_mfma_f32_32x32x16_bf16 v[32:47], a[0:3], a[52:55], 0
    ds_read_b64_tr_b16 a[72:73], v13 offset:6144
    ds_read_b64_tr_b16 a[74:75], v13 offset:6656
    ds_read_b64_tr_b16 a[76:77], v13 offset:6208
    ds_read_b64_tr_b16 a[78:79], v13 offset:6720
    s_add_u32 s69, s69, 3072
    buffer_load_dwordx2 v[88:89], v4, s[20:23], s69 offen offset:0 nt
    buffer_load_dwordx2 v[90:91], v4, s[20:23], s69 offen offset:512 nt
    s_waitcnt lgkmcnt(8)
    v_mfma_f32_32x32x16_bf16 v[16:31], a[4:7], a[56:59], v[16:31]
    v_mfma_f32_32x32x16_bf16 v[32:47], a[4:7], a[60:63], v[32:47]
    ds_read_b64_tr_b16 a[80:81], v13 offset:8192
    ds_read_b64_tr_b16 a[82:83], v13 offset:8704
    ds_read_b64_tr_b16 a[84:85], v13 offset:8256
    ds_read_b64_tr_b16 a[86:87], v13 offset:8768
    buffer_load_dwordx2 v[92:93], v4, s[20:23], s69 offen offset:1024 nt
    buffer_load_dwordx2 v[94:95], v4, s[20:23], s69 offen offset:1536 nt
    s_waitcnt lgkmcnt(8)
    v_mfma_f32_32x32x16_bf16 v[16:31], a[8:11], a[64:67], v[16:31]
    v_mfma_f32_32x32x16_bf16 v[32:47], a[8:11], a[68:71], v[32:47]
    ds_read_b64_tr_b16 a[88:89], v13 offset:10240
    ds_read_b64_tr_b16 a[90:91], v13 offset:10752
    ds_read_b64_tr_b16 a[92:93], v13 offset:10304
    ds_read_b64_tr_b16 a[94:95], v13 offset:10816
    buffer_load_dwordx2 v[96:97], v4, s[20:23], s69 offen offset:2048 nt
    buffer_load_dwordx2 v[98:99], v4, s[20:23], s69 offen offset:2560 nt
    s_waitcnt lgkmcnt(8)
    v_mfma_f32_32x32x16_bf16 v[16:31], a[12:15], a[72:75], v[16:31]
    v_mfma_f32_32x32x16_bf16 v[32:47], a[12:15], a[76:79], v[32:47]
    s_add_u32 s69, s69, 3072
    buffer_load_dwordx2 v[100:101], v4, s[20:23], s69 offen offset:0 nt
    buffer_load_dwordx2 v[102:103], v4, s[20:23], s69 offen offset:512 nt
    s_waitcnt lgkmcnt(4)
    v_mfma_f32_32x32x16_bf16 v[16:31], a[16:19], a[80:83], v[16:31]
    v_mfma_f32_32x32x16_bf16 v[32:47], a[16:19], a[84:87], v[32:47]
    buffer_load_dwordx2 v[104:105], v4, s[20:23], s69 offen offset:1024 nt
    buffer_load_dwordx2 v[106:107], v4, s[20:23], s69 offen offset:1536 nt
    s_waitcnt lgkmcnt(0)
    v_mfma_f32_32x32x16_bf16 v[16:31], a[20:23], a[88:91], v[16:31]
    v_mfma_f32_32x32x16_bf16 v[32:47], a[20:23], a[92:95], v[32:47]
    buffer_load_dwordx2 v[108:109], v4, s[20:23], s69 offen offset:2048 nt
    buffer_load_dwordx2 v[110:111], v4, s[20:23], s69 offen offset:2560 nt
    s_lshl_b32 s57, s3, 9
    s_add_u32 s57, s57, 161792
    v_lshl_add_u32 v12, v0, 2, s57
    s_nop 5
    v_add_f32 v16, v16, v18
    v_add_f32 v17, v17, v19
    v_add_f32 v32, v32, v34
    v_add_f32 v33, v33, v35
    s_mov_b32 exec_hi, 0
    ds_write_b32 v12, v16 offset:0
    ds_write_b32 v12, v17 offset:256
    ds_write_b32 v12, v32 offset:128
    ds_write_b32 v12, v33 offset:384
    s_mov_b32 exec_hi, -1
    s_waitcnt vmcnt(24)
    v_cmp_eq_u32 vcc, 0, v2
    s_cbranch_vccz L_nok_2
    s_mov_b32 s88, 0
L_nsp_3:
    buffer_load_dwordx2 v[2:3], off, s[44:47], 0 sc1
    s_waitcnt vmcnt(0)
    v_cmp_eq_u32 vcc, 0, v2
    s_cbranch_vccz L_nok_2
    s_add_u32 s88, s88, 1
    s_cmp_lt_u32 s88, 262144
    s_cbranch_scc1 L_nsp_3
L_nok_2:
    s_waitcnt lgkmcnt(0)
    s_barrier
    s_cmp_eq_u32 s3, 0
    s_cbranch_scc0 L_red_4
    v_lshlrev_b32 v12, 3, v0
    v_add_u32 v12, 161792, v12
    ds_read_b64 v[16:17], v12 offset:0
    ds_read_b64 v[18:19], v12 offset:512
    ds_read_b64 v[20:21], v12 offset:1024
    ds_read_b64 v[22:23], v12 offset:1536
    v_lshrrev_b32 v13, 5, v0
    v_and_b32 v14, 31, v0
    v_mul_u32_u24 v13, 12288, v13
    v_lshl_add_u32 v13, v14, 4, v13
    s_mul_i32 s57, s66, 24576
    s_lshl_b32 s58, s65, 9
    s_add_u32 s57, s57, s58
    s_add_u32 s57, s57, 19464192
    s_waitcnt lgkmcnt(0)
    v_pk_add_f32 v[16:17], v[16:17], v[18:19]
    v_pk_add_f32 v[20:21], v[20:21], v[22:23]
    v_pk_add_f32 v[16:17], v[16:17], v[20:21]
    v_mov_b32 v18, v2
    v_mov_b32 v19, v3
    buffer_store_dwordx4 v[16:19], v13, s[48:51], s57 offen sc1
L_red_4:
L_A_ln:
    s_waitcnt vmcnt(21)
    v_lshlrev_b32 v112, 16, v64
    v_and_b32 v113, s91, v64
    v_lshlrev_b32 v114, 16, v65
    v_and_b32 v115, s91, v65
    v_lshlrev_b32 v116, 16, v66
    v_and_b32 v117, s91, v66
    v_lshlrev_b32 v118, 16, v67
    v_and_b32 v119, s91, v67
    v_lshlrev_b32 v120, 16, v68
    v_and_b32 v121, s91, v68
    v_lshlrev_b32 v122, 16, v69
    v_and_b32 v123, s91, v69
    v_pk_add_f32 v[16:17], v[112:113], v[114:115]
    s_waitcnt vmcnt(18)
    v_lshlrev_b32 v124, 16, v70
    v_and_b32 v125, s91, v70
    v_lshlrev_b32 v126, 16, v71
    v_and_b32 v127, s91, v71
    v_lshlrev_b32 v128, 16, v72
    v_and_b32 v129, s91, v72
    v_lshlrev_b32 v130, 16, v73
    v_and_b32 v131, s91, v73
    v_lshlrev_b32 v132, 16, v74
    v_and_b32 v133, s91, v74
    v_lshlrev_b32 v134, 16, v75
    v_and_b32 v135, s91, v75
    v_pk_add_f32 v[18:19], v[124:125], v[126:127]
    s_waitcnt vmcnt(15)
    v_lshlrev_b32 v136, 16, v76
    v_and_b32 v137, s91, v76
    v_lshlrev_b32 v138, 16, v77
    v_and_b32 v139, s91, v77
    v_lshlrev_b32 v140, 16, v78
    v_and_b32 v141, s91, v78
    v_lshlrev_b32 v142, 16, v79
    v_and_b32 v143, s91, v79
    v_lshlrev_b32 v144, 16, v80
    v_and_b32 v145, s91, v80
    v_lshlrev_b32 v146, 16, v81
    v_and_b32 v147, s91, v81
    v_pk_add_f32 v[20:21], v[136:137], v[138:139]
    s_waitcnt vmcnt(12)
    v_lshlrev_b32 v148, 16, v82
    v_and_b32 v149, s91, v82
    v_lshlrev_b32 v150, 16, v83
    v_and_b32 v151, s91, v83
    v_lshlrev_b32 v152, 16, v84
    v_and_b32 v153, s91, v84
    v_lshlrev_b32 v154, 16, v85
    v_and_b32 v155, s91, v85
    v_lshlrev_b32 v156, 16, v86
    v_and_b32 v157, s91, v86
    v_lshlrev_b32 v158, 16, v87
    v_and_b32 v159, s91, v87
    v_pk_add_f32 v[22:23], v[148:149], v[150:151]
    s_waitcnt vmcnt(9)
    v_lshlrev_b32 v160, 16, v88
    v_and_b32 v161, s91, v88
    v_lshlrev_b32 v162, 16, v89
    v_and_b32 v163, s91, v89
    v_lshlrev_b32 v164, 16, v90
    v_and_b32 v165, s91, v90
    v_lshlrev_b32 v166, 16, v91
    v_and_b32 v167, s91, v91
    v_lshlrev_b32 v168, 16, v92
    v_and_b32 v169, s91, v92
    v_lshlrev_b32 v170, 16, v93
    v_and_b32 v171, s91, v93
    v_pk_add_f32 v[24:25], v[160:161], v[162:163]
    s_waitcnt vmcnt(6)
    v_lshlrev_b32 v172, 16, v94
    v_and_b32 v173, s91, v94
    v_lshlrev_b32 v174, 16, v95
    v_and_b32 v175, s91, v95
    v_lshlrev_b32 v176, 16, v96
    v_and_b32 v177, s91, v96
    v_lshlrev_b32 v178, 16, v97
    v_and_b32 v179, s91, v97
    v_lshlrev_b32 v180, 16, v98
    v_and_b32 v181, s91, v98
    v_lshlrev_b32 v182, 16, v99
    v_and_b32 v183, s91, v99
    v_pk_add_f32 v[26:27], v[172:173], v[174:175]
    s_waitcnt vmcnt(3)
    v_lshlrev_b32 v184, 16, v100
    v_and_b32 v185, s91, v100
    v_lshlrev_b32 v186, 16, v101
    v_and_b32 v187, s91, v101
    v_lshlrev_b32 v188, 16, v102
    v_and_b32 v189, s91, v102
    v_lshlrev_b32 v190, 16, v103
    v_and_b32 v191, s91, v103
    v_lshlrev_b32 v192, 16, v104
    v_and_b32 v193, s91, v104
    v_lshlrev_b32 v194, 16, v105
    v_and_b32 v195, s91, v105
    v_pk_add_f32 v[28:29], v[184:185], v[186:187]
    s_waitcnt vmcnt(0)
    v_lshlrev_b32 v196, 16, v106
    v_and_b32 v197, s91, v106
    v_lshlrev_b32 v198, 16, v107
    v_and_b32 v199, s91, v107
    v_lshlrev_b32 v200, 16, v108
    v_and_b32 v201, s91, v108
    v_lshlrev_b32 v202, 16, v109
    v_and_b32 v203, s91, v109
    v_lshlrev_b32 v204, 16, v110
    v_and_b32 v205, s91, v110
    v_lshlrev_b32 v206, 16, v111
    v_and_b32 v207, s91, v111
    v_pk_add_f32 v[30:31], v[196:197], v[198:199]
    v_pk_add_f32 v[16:17], v[16:17], v[116:117]
    v_pk_add_f32 v[18:19], v[18:19], v[128:129]
    v_pk_add_f32 v[20:21], v[20:21], v[140:141]
    v_pk_add_f32 v[22:23], v[22:23], v[152:153]
    v_pk_add_f32 v[24:25], v[24:25], v[164:165]
    v_pk_add_f32 v[26:27], v[26:27], v[176:177]
    v_pk_add_f32 v[28:29], v[28:29], v[188:189]
    v_pk_add_f32 v[30:31], v[30:31], v[200:201]
    v_pk_add_f32 v[16:17], v[16:17], v[118:119]
    v_pk_add_f32 v[18:19], v[18:19], v[130:131]
    v_pk_add_f32 v[20:21], v[20:21], v[142:143]
    v_pk_add_f32 v[22:23], v[22:23], v[154:155]
    v_pk_add_f32 v[24:25], v[24:25], v[166:167]
    v_pk_add_f32 v[26:27], v[26:27], v[178:179]
    v_pk_add_f32 v[28:29], v[28:29], v[190:191]
    v_pk_add_f32 v[30:31], v[30:31], v[202:203]
    v_pk_add_f32 v[16:17], v[16:17], v[120:121]
    v_pk_add_f32 v[18:19], v[18:19], v[132:133]
    v_pk_add_f32 v[20:21], v[20:21], v[144:145]
    v_pk_add_f32 v[22:23], v[22:23], v[156:157]
    v_pk_add_f32 v[24:25], v[24:25], v[168:169]
    v_pk_add_f32 v[26:27], v[26:27], v[180:181]
    v_pk_add_f32 v[28:29], v[28:29], v[192:193]
    v_pk_add_f32 v[30:31], v[30:31], v[204:205]
    v_pk_add_f32 v[16:17], v[16:17], v[122:123]
    v_pk_add_f32 v[18:19], v[18:19], v[134:135]
    v_pk_add_f32 v[20:21], v[20:21], v[146:147]
    v_pk_add_f32 v[22:23], v[22:23], v[158:159]
    v_pk_add_f32 v[24:25], v[24:25], v[170:171]
    v_pk_add_f32 v[26:27], v[26:27], v[182:183]
    v_pk_add_f32 v[28:29], v[28:29], v[194:195]
    v_pk_add_f32 v[30:31], v[30:31], v[206:207]
    v_add_f32 v32, v16, v17
    v_add_f32 v33, v18, v19
    v_add_f32 v34, v20, v21
    v_add_f32 v35, v22, v23
    v_add_f32 v36, v24, v25
    v_add_f32 v37, v26, v27
    v_add_f32 v38, v28, v29
    v_add_f32 v39, v30, v31
    v_lshrrev_b32 v40, 2, v0
    v_and_b32 v41, 1, v0
    v_permlane32_swap_b32 v32, v36
    v_permlane32_swap_b32 v33, v37
    v_permlane32_swap_b32 v34, v38
    v_permlane32_swap_b32 v35, v39
    v_lshl_or_b32 v42, v40, 1, v41
    v_and_b32 v43, 7, v42
    v_add_f32 v32, v32, v36
    v_add_f32 v33, v33, v37
    v_add_f32 v34, v34, v38
    v_add_f32 v35, v35, v39
    v_lshlrev_b32 v42, 7, v42
    v_and_b32 v41, 2, v0
    v_permlane16_swap_b32 v32, v34
    v_permlane16_swap_b32 v33, v35
    v_lshl_add_u32 v42, v41, 2, v42
    s_mul_i32 s57, s3, 12288
    v_add_f32 v32, v32, v34
    v_add_f32 v33, v33, v35
    s_add_u32 s57, s57, 98304
    v_add_u32 v42, s57, v42
    v_add_f32_dpp v32, v32, v32 row_ror:8 row_mask:0xf bank_mask:0xf
    v_add_f32_dpp v33, v33, v33 row_ror:8 row_mask:0xf bank_mask:0xf
    s_mov_b32 s58, 0x3aaaaaab
    v_add_f32_dpp v32, v32, v32 row_ror:4 row_mask:0xf bank_mask:0xf
    v_add_f32_dpp v33, v33, v33 row_ror:4 row_mask:0xf bank_mask:0xf
    s_nop 0
    v_add_f32_dpp v32, v32, v32 row_ror:2 row_mask:0xf bank_mask:0xf
    v_add_f32_dpp v33, v33, v33 row_ror:2 row_mask:0xf bank_mask:0xf
    s_nop 0
    v_add_f32_dpp v32, v32, v32 row_ror:1 row_mask:0xf bank_mask:0xf
    v_add_f32_dpp v33, v33, v33 row_ror:1 row_mask:0xf bank_mask:0xf
    v_mul_f32 v32, s58, v32
    v_mul_f32 v33, s58, v33
    v_xor_b32 v41, 0, v43
    v_lshl_add_u32 v48, v41, 4, v42
    v_xor_b32 v41, 1, v43
    v_lshl_add_u32 v49, v41, 4, v42
    v_xor_b32 v41, 2, v43
    v_lshl_add_u32 v50, v41, 4, v42
    v_xor_b32 v41, 3, v43
    v_lshl_add_u32 v51, v41, 4, v42
    v_readlane_b32 s8, v32, 0
    v_readlane_b32 s9, v33, 0
    v_readlane_b32 s10, v32, 16
    v_readlane_b32 s11, v33, 16
    v_readlane_b32 s12, v32, 32
    v_readlane_b32 s13, v33, 32
    v_readlane_b32 s14, v32, 48
    v_readlane_b32 s15, v33, 48
    v_xor_b32 v41, 4, v43
    v_lshl_add_u32 v52, v41, 4, v42
    v_xor_b32 v41, 5, v43
    v_lshl_add_u32 v53, v41, 4, v42
    v_xor_b32 v41, 6, v43
    v_lshl_add_u32 v54, v41, 4, v42
    v_xor_b32 v41, 7, v43
    v_lshl_add_u32 v55, v41, 4, v42
    v_pk_add_f32 v[112:113], v[112:113], s[8:9] op_sel_hi:[1,0] neg_lo:[0,1] neg_hi:[0,1]
    v_pk_add_f32 v[124:125], v[124:125], s[8:9] op_sel:[0,1] op_sel_hi:[1,1] neg_lo:[0,1] neg_hi:[0,1]
    v_pk_add_f32 v[136:137], v[136:137], s[10:11] op_sel_hi:[1,0] neg_lo:[0,1] neg_hi:[0,1]
    v_pk_add_f32 v[148:149], v[148:149], s[10:11] op_sel:[0,1] op_sel_hi:[1,1] neg_lo:[0,1] neg_hi:[0,1]
    v_pk_add_f32 v[160:161], v[160:161], s[12:13] op_sel_hi:[1,0] neg_lo:[0,1] neg_hi:[0,1]
    v_pk_add_f32 v[172:173], v[172:173], s[12:13] op_sel:[0,1] op_sel_hi:[1,1] neg_lo:[0,1] neg_hi:[0,1]
    v_pk_add_f32 v[184:185], v[184:185], s[14:15] op_sel_hi:[1,0] neg_lo:[0,1] neg_hi:[0,1]
    v_pk_add_f32 v[196:197], v[196:197], s[14:15] op_sel:[0,1] op_sel_hi:[1,1] neg_lo:[0,1] neg_hi:[0,1]
    v_pk_add_f32 v[114:115], v[114:115], s[8:9] op_sel_hi:[1,0] neg_lo:[0,1] neg_hi:[0,1]
    v_pk_add_f32 v[126:127], v[126:127], s[8:9] op_sel:[0,1] op_sel_hi:[1,1] neg_lo:[0,1] neg_hi:[0,1]
    v_pk_add_f32 v[138:139], v[138:139], s[10:11] op_sel_hi:[1,0] neg_lo:[0,1] neg_hi:[0,1]
    v_pk_add_f32 v[150:151], v[150:151], s[10:11] op_sel:[0,1] op_sel_hi:[1,1] neg_lo:[0,1] neg_hi:[0,1]
    v_pk_add_f32 v[162:163], v[162:163], s[12:13] op_sel_hi:[1,0] neg_lo:[0,1] neg_hi:[0,1]
    v_pk_add_f32 v[174:175], v[174:175], s[12:13] op_sel:[0,1] op_sel_hi:[1,1] neg_lo:[0,1] neg_hi:[0,1]
    v_pk_add_f32 v[186:187], v[186:187], s[14:15] op_sel_hi:[1,0] neg_lo:[0,1] neg_hi:[0,1]
    v_pk_add_f32 v[198:199], v[198:199], s[14:15] op_sel:[0,1] op_sel_hi:[1,1] neg_lo:[0,1] neg_hi:[0,1]
    v_pk_add_f32 v[116:117], v[116:117], s[8:9] op_sel_hi:[1,0] neg_lo:[0,1] neg_hi:[0,1]
    v_pk_add_f32 v[128:129], v[128:129], s[8:9] op_sel:[0,1] op_sel_hi:[1,1] neg_lo:[0,1] neg_hi:[0,1]
    v_pk_add_f32 v[140:141], v[140:141], s[10:11] op_sel_hi:[1,0] neg_lo:[0,1] neg_hi:[0,1]
    v_pk_add_f32 v[152:153], v[152:153], s[10:11] op_sel:[0,1] op_sel_hi:[1,1] neg_lo:[0,1] neg_hi:[0,1]
    v_pk_add_f32 v[164:165], v[164:165], s[12:13] op_sel_hi:[1,0] neg_lo:[0,1] neg_hi:[0,1]
    v_pk_add_f32 v[176:177], v[176:177], s[12:13] op_sel:[0,1] op_sel_hi:[1,1] neg_lo:[0,1] neg_hi:[0,1]
    v_pk_add_f32 v[188:189], v[188:189], s[14:15] op_sel_hi:[1,0] neg_lo:[0,1] neg_hi:[0,1]
    v_pk_add_f32 v[200:201], v[200:201], s[14:15] op_sel:[0,1] op_sel_hi:[1,1] neg_lo:[0,1] neg_hi:[0,1]
    v_pk_add_f32 v[118:119], v[118:119], s[8:9] op_sel_hi:[1,0] neg_lo:[0,1] neg_hi:[0,1]
    v_pk_add_f32 v[130:131], v[130:131], s[8:9] op_sel:[0,1] op_sel_hi:[1,1] neg_lo:[0,1] neg_hi:[0,1]
    v_pk_add_f32 v[142:143], v[142:143], s[10:11] op_sel_hi:[1,0] neg_lo:[0,1] neg_hi:[0,1]
    v_pk_add_f32 v[154:155], v[154:155], s[10:11] op_sel:[0,1] op_sel_hi:[1,1] neg_lo:[0,1] neg_hi:[0,1]
    v_pk_add_f32 v[166:167], v[166:167], s[12:13] op_sel_hi:[1,0] neg_lo:[0,1] neg_hi:[0,1]
    v_pk_add_f32 v[178:179], v[178:179], s[12:13] op_sel:[0,1] op_sel_hi:[1,1] neg_lo:[0,1] neg_hi:[0,1]
    v_pk_add_f32 v[190:191], v[190:191], s[14:15] op_sel_hi:[1,0] neg_lo:[0,1] neg_hi:[0,1]
    v_pk_add_f32 v[202:203], v[202:203], s[14:15] op_sel:[0,1] op_sel_hi:[1,1] neg_lo:[0,1] neg_hi:[0,1]
    v_pk_add_f32 v[120:121], v[120:121], s[8:9] op_sel_hi:[1,0] neg_lo:[0,1] neg_hi:[0,1]
    v_pk_add_f32 v[132:133], v[132:133], s[8:9] op_sel:[0,1] op_sel_hi:[1,1] neg_lo:[0,1] neg_hi:[0,1]
    v_pk_add_f32 v[144:145], v[144:145], s[10:11] op_sel_hi:[1,0] neg_lo:[0,1] neg_hi:[0,1]
    v_pk_add_f32 v[156:157], v[156:157], s[10:11] op_sel:[0,1] op_sel_hi:[1,1] neg_lo:[0,1] neg_hi:[0,1]
    v_pk_add_f32 v[168:169], v[168:169], s[12:13] op_sel_hi:[1,0] neg_lo:[0,1] neg_hi:[0,1]
    v_pk_add_f32 v[180:181], v[180:181], s[12:13] op_sel:[0,1] op_sel_hi:[1,1] neg_lo:[0,1] neg_hi:[0,1]
    v_pk_add_f32 v[192:193], v[192:193], s[14:15] op_sel_hi:[1,0] neg_lo:[0,1] neg_hi:[0,1]
    v_pk_add_f32 v[204:205], v[204:205], s[14:15] op_sel:[0,1] op_sel_hi:[1,1] neg_lo:[0,1] neg_hi:[0,1]
    v_pk_add_f32 v[122:123], v[122:123], s[8:9] op_sel_hi:[1,0] neg_lo:[0,1] neg_hi:[0,1]
    v_pk_add_f32 v[134:135], v[134:135], s[8:9] op_sel:[0,1] op_sel_hi:[1,1] neg_lo:[0,1] neg_hi:[0,1]
    v_cmp_eq_u32 vcc, 0, v2
    s_cbranch_vccz L_nok_5
    s_mov_b32 s88, 0
L_nsp_6:
    buffer_load_dwordx2 v[2:3], off, s[44:47], 0 sc1
    s_waitcnt vmcnt(0)
    v_cmp_eq_u32 vcc, 0, v2
    s_cbranch_vccz L_nok_5
    s_add_u32 s88, s88, 1
    s_cmp_lt_u32 s88, 262144
    s_cbranch_scc1 L_nsp_6
L_nok_5:
    s_lshr_b32 s56, s64, 5
    s_mul_i32 s56, s56, 12288
    s_mul_i32 s59, s3, 3072
    s_add_u32 s56, s56, s59
    s_add_u32 s94, s56, 19464192
    s_add_u32 s95, s94, 24576
    buffer_load_dwordx4 v[232:235], v1, s[48:51], s94 offen offset:0 sc1
    buffer_load_dwordx4 v[236:239], v1, s[48:51], s95 offen offset:0 sc1
    buffer_load_dwordx4 v[240:243], v1, s[48:51], s94 offen offset:1024 sc1
    buffer_load_dwordx4 v[244:247], v1, s[48:51], s95 offen offset:1024 sc1
    buffer_load_dwordx4 v[248:251], v1, s[48:51], s94 offen offset:2048 sc1
    buffer_load_dwordx4 v[252:255], v1, s[48:51], s95 offen offset:2048 sc1
    v_pk_add_f32 v[146:147], v[146:147], s[10:11] op_sel_hi:[1,0] neg_lo:[0,1] neg_hi:[0,1]
    v_pk_add_f32 v[158:159], v[158:159], s[10:11] op_sel:[0,1] op_sel_hi:[1,1] neg_lo:[0,1] neg_hi:[0,1]
    v_pk_add_f32 v[170:171], v[170:171], s[12:13] op_sel_hi:[1,0] neg_lo:[0,1] neg_hi:[0,1]
    v_pk_add_f32 v[182:183], v[182:183], s[12:13] op_sel:[0,1] op_sel_hi:[1,1] neg_lo:[0,1] neg_hi:[0,1]
    v_pk_add_f32 v[194:195], v[194:195], s[14:15] op_sel_hi:[1,0] neg_lo:[0,1] neg_hi:[0,1]
    v_pk_add_f32 v[206:207], v[206:207], s[14:15] op_sel:[0,1] op_sel_hi:[1,1] neg_lo:[0,1] neg_hi:[0,1]
    v_pk_mul_f32 v[16:17], v[112:113], v[112:113]
    v_pk_mul_f32 v[18:19], v[124:125], v[124:125]
    v_pk_mul_f32 v[20:21], v[136:137], v[136:137]
    v_pk_mul_f32 v[22:23], v[148:149], v[148:149]
    v_pk_mul_f32 v[24:25], v[160:161], v[160:161]
    v_pk_mul_f32 v[26:27], v[172:173], v[172:173]
    v_pk_mul_f32 v[28:29], v[184:185], v[184:185]
    v_pk_mul_f32 v[30:31], v[196:197], v[196:197]
    v_pk_fma_f32 v[16:17], v[114:115], v[114:115], v[16:17]
    v_pk_fma_f32 v[18:19], v[126:127], v[126:127], v[18:19]
    v_pk_fma_f32 v[20:21], v[138:139], v[138:139], v[20:21]
    v_pk_fma_f32 v[22:23], v[150:151], v[150:151], v[22:23]
    v_pk_fma_f32 v[24:25], v[162:163], v[162:163], v[24:25]
    v_pk_fma_f32 v[26:27], v[174:175], v[174:175], v[26:27]
    v_pk_fma_f32 v[28:29], v[186:187], v[186:187], v[28:29]
    v_pk_fma_f32 v[30:31], v[198:199], v[198:199], v[30:31]
    v_pk_fma_f32 v[16:17], v[116:117], v[116:117], v[16:17]
    v_pk_fma_f32 v[18:19], v[128:129], v[128:129], v[18:19]
    v_pk_fma_f32 v[20:21], v[140:141], v[140:141], v[20:21]
    v_pk_fma_f32 v[22:23], v[152:153], v[152:153], v[22:23]
    v_pk_fma_f32 v[24:25], v[164:165], v[164:165], v[24:25]
    v_pk_fma_f32 v[26:27], v[176:177], v[176:177], v[26:27]
    v_pk_fma_f32 v[28:29], v[188:189], v[188:189], v[28:29]
    v_pk_fma_f32 v[30:31], v[200:201], v[200:201], v[30:31]
    v_pk_fma_f32 v[16:17], v[118:119], v[118:119], v[16:17]
    v_pk_fma_f32 v[18:19], v[130:131], v[130:131], v[18:19]
    v_pk_fma_f32 v[20:21], v[142:143], v[142:143], v[20:21]
    v_pk_fma_f32 v[22:23], v[154:155], v[154:155], v[22:23]
    v_pk_fma_f32 v[24:25], v[166:167], v[166:167], v[24:25]
    v_pk_fma_f32 v[26:27], v[178:179], v[178:179], v[26:27]
    v_pk_fma_f32 v[28:29], v[190:191], v[190:191], v[28:29]
    v_pk_fma_f32 v[30:31], v[202:203], v[202:203], v[30:31]
    v_pk_fma_f32 v[16:17], v[120:121], v[120:121], v[16:17]
    v_pk_fma_f32 v[18:19], v[132:133], v[132:133], v[18:19]
    v_pk_fma_f32 v[20:21], v[144:145], v[144:145], v[20:21]
    v_pk_fma_f32 v[22:23], v[156:157], v[156:157], v[22:23]
    v_pk_fma_f32 v[24:25], v[168:169], v[168:169], v[24:25]
    v_pk_fma_f32 v[26:27], v[180:181], v[180:181], v[26:27]
    v_pk_fma_f32 v[28:29], v[192:193], v[192:193], v[28:29]
    v_pk_fma_f32 v[30:31], v[204:205], v[204:205], v[30:31]
    v_pk_fma_f32 v[16:17], v[122:123], v[122:123], v[16:17]
    v_pk_fma_f32 v[18:19], v[134:135], v[134:135], v[18:19]
    v_pk_fma_f32 v[20:21], v[146:147], v[146:147], v[20:21]
    v_pk_fma_f32 v[22:23], v[158:159], v[158:159], v[22:23]
    v_pk_fma_f32 v[24:25], v[170:171], v[170:171], v[24:25]
    v_pk_fma_f32 v[26:27], v[182:183], v[182:183], v[26:27]
    v_pk_fma_f32 v[28:29], v[194:195], v[194:195], v[28:29]
    v_pk_fma_f32 v[30:31], v[206:207], v[206:207], v[30:31]
    v_add_f32 v32, v16, v17
    v_add_f32 v33, v18, v19
    v_add_f32 v34, v20, v21
    v_add_f32 v35, v22, v23
    v_add_f32 v36, v24, v25
    v_add_f32 v37, v26, v27
    v_add_f32 v38, v28, v29
    v_add_f32 v39, v30, v31
    v_and_b32 v44, 7, v0
    v_lshrrev_b32 v45, 3, v0
    v_permlane32_swap_b32 v32, v36
    v_permlane32_swap_b32 v33, v37
    v_permlane32_swap_b32 v34, v38
    v_permlane32_swap_b32 v35, v39
    v_xor_b32 v56, v44, v45
    v_lshlrev_b32 v56, 4, v56
    v_add_f32 v32, v32, v36
    v_add_f32 v33, v33, v37
    v_add_f32 v34, v34, v38
    v_add_f32 v35, v35, v39
    v_lshl_add_u32 v56, v45, 7, v56
    v_add_u32 v56, s57, v56
    v_permlane16_swap_b32 v32, v34
    v_permlane16_swap_b32 v33, v35
    v_lshrrev_b32 v57, 1, v45
    v_lshlrev_b32 v57, 10, v57
    v_add_f32 v32, v32, v34
    v_add_f32 v33, v33, v35
    v_and_b32 v45, 1, v45
    v_lshl_add_u32 v57, v45, 9, v57
    v_add_f32_dpp v32, v32, v32 row_ror:8 row_mask:0xf bank_mask:0xf
    v_add_f32_dpp v33, v33, v33 row_ror:8 row_mask:0xf bank_mask:0xf
    v_lshl_add_u32 v57, v44, 4, v57
    v_mov_b32 v41, 0x3727c5ac
    v_add_f32_dpp v32, v32, v32 row_ror:4 row_mask:0xf bank_mask:0xf
    v_add_f32_dpp v33, v33, v33 row_ror:4 row_mask:0xf bank_mask:0xf
    s_nop 0
    v_add_f32_dpp v32, v32, v32 row_ror:2 row_mask:0xf bank_mask:0xf
    v_add_f32_dpp v33, v33, v33 row_ror:2 row_mask:0xf bank_mask:0xf
    s_nop 0
    v_add_f32_dpp v32, v32, v32 row_ror:1 row_mask:0xf bank_mask:0xf
    v_add_f32_dpp v33, v33, v33 row_ror:1 row_mask:0xf bank_mask:0xf
    v_fma_f32 v32, v32, s58, v41
    v_fma_f32 v33, v33, s58, v41
    v_rsq_f32 v32, v32
    v_rsq_f32 v33, v33
    s_mul_i32 s68, s64, 49152
    s_lshl_b32 s57, s3, 7
    s_add_u32 s68, s68, s57
    s_add_u32 s68, s68, 5242880
    v_readlane_b32 s8, v32, 0
    v_readlane_b32 s9, v33, 0
    v_readlane_b32 s10, v32, 16
    v_readlane_b32 s11, v33, 16
    v_readlane_b32 s12, v32, 32
    v_readlane_b32 s13, v33, 32
    v_readlane_b32 s14, v32, 48
    v_readlane_b32 s15, v33, 48
    v_pk_mul_f32 v[112:113], v[112:113], s[8:9] op_sel_hi:[1,0]
    v_pk_mul_f32 v[124:125], v[124:125], s[8:9] op_sel:[0,1] op_sel_hi:[1,1]
    v_pk_mul_f32 v[136:137], v[136:137], s[10:11] op_sel_hi:[1,0]
    v_pk_mul_f32 v[148:149], v[148:149], s[10:11] op_sel:[0,1] op_sel_hi:[1,1]
    v_pk_mul_f32 v[160:161], v[160:161], s[12:13] op_sel_hi:[1,0]
    v_pk_mul_f32 v[172:173], v[172:173], s[12:13] op_sel:[0,1] op_sel_hi:[1,1]
    v_pk_mul_f32 v[184:185], v[184:185], s[14:15] op_sel_hi:[1,0]
    v_pk_mul_f32 v[196:197], v[196:197], s[14:15] op_sel:[0,1] op_sel_hi:[1,1]
    v_pk_mul_f32 v[114:115], v[114:115], s[8:9] op_sel_hi:[1,0]
    v_pk_mul_f32 v[126:127], v[126:127], s[8:9] op_sel:[0,1] op_sel_hi:[1,1]
    v_pk_mul_f32 v[138:139], v[138:139], s[10:11] op_sel_hi:[1,0]
    v_pk_mul_f32 v[150:151], v[150:151], s[10:11] op_sel:[0,1] op_sel_hi:[1,1]
    v_pk_mul_f32 v[162:163], v[162:163], s[12:13] op_sel_hi:[1,0]
    v_pk_mul_f32 v[174:175], v[174:175], s[12:13] op_sel:[0,1] op_sel_hi:[1,1]
    v_pk_mul_f32 v[186:187], v[186:187], s[14:15] op_sel_hi:[1,0]
    v_pk_mul_f32 v[198:199], v[198:199], s[14:15] op_sel:[0,1] op_sel_hi:[1,1]
    v_pk_mul_f32 v[116:117], v[116:117], s[8:9] op_sel_hi:[1,0]
    v_pk_mul_f32 v[128:129], v[128:129], s[8:9] op_sel:[0,1] op_sel_hi:[1,1]
    v_pk_mul_f32 v[140:141], v[140:141], s[10:11] op_sel_hi:[1,0]
    v_pk_mul_f32 v[152:153], v[152:153], s[10:11] op_sel:[0,1] op_sel_hi:[1,1]
    v_pk_mul_f32 v[164:165], v[164:165], s[12:13] op_sel_hi:[1,0]
    v_pk_mul_f32 v[176:177], v[176:177], s[12:13] op_sel:[0,1] op_sel_hi:[1,1]
    v_pk_mul_f32 v[188:189], v[188:189], s[14:15] op_sel_hi:[1,0]
    v_pk_mul_f32 v[200:201], v[200:201], s[14:15] op_sel:[0,1] op_sel_hi:[1,1]
    v_pk_mul_f32 v[118:119], v[118:119], s[8:9] op_sel_hi:[1,0]
    v_pk_mul_f32 v[130:131], v[130:131], s[8:9] op_sel:[0,1] op_sel_hi:[1,1]
    v_pk_mul_f32 v[142:143], v[142:143], s[10:11] op_sel_hi:[1,0]
    v_pk_mul_f32 v[154:155], v[154:155], s[10:11] op_sel:[0,1] op_sel_hi:[1,1]
    v_pk_mul_f32 v[166:167], v[166:167], s[12:13] op_sel_hi:[1,0]
    v_pk_mul_f32 v[178:179], v[178:179], s[12:13] op_sel:[0,1] op_sel_hi:[1,1]
    v_pk_mul_f32 v[190:191], v[190:191], s[14:15] op_sel_hi:[1,0]
    v_pk_mul_f32 v[202:203], v[202:203], s[14:15] op_sel:[0,1] op_sel_hi:[1,1]
    v_pk_mul_f32 v[120:121], v[120:121], s[8:9] op_sel_hi:[1,0]
    v_pk_mul_f32 v[132:133], v[132:133], s[8:9] op_sel:[0,1] op_sel_hi:[1,1]
    v_pk_mul_f32 v[144:145], v[144:145], s[10:11] op_sel_hi:[1,0]
    v_pk_mul_f32 v[156:157], v[156:157], s[10:11] op_sel:[0,1] op_sel_hi:[1,1]
    v_pk_mul_f32 v[168:169], v[168:169], s[12:13] op_sel_hi:[1,0]
    v_pk_mul_f32 v[180:181], v[180:181], s[12:13] op_sel:[0,1] op_sel_hi:[1,1]
    v_pk_mul_f32 v[192:193], v[192:193], s[14:15] op_sel_hi:[1,0]
    v_pk_mul_f32 v[204:205], v[204:205], s[14:15] op_sel:[0,1] op_sel_hi:[1,1]
    v_pk_mul_f32 v[122:123], v[122:123], s[8:9] op_sel_hi:[1,0]
    v_pk_mul_f32 v[134:135], v[134:135], s[8:9] op_sel:[0,1] op_sel_hi:[1,1]
    v_pk_mul_f32 v[146:147], v[146:147], s[10:11] op_sel_hi:[1,0]
    v_pk_mul_f32 v[158:159], v[158:159], s[10:11] op_sel:[0,1] op_sel_hi:[1,1]
    v_pk_mul_f32 v[170:171], v[170:171], s[12:13] op_sel_hi:[1,0]
    v_pk_mul_f32 v[182:183], v[182:183], s[12:13] op_sel:[0,1] op_sel_hi:[1,1]
    v_pk_mul_f32 v[194:195], v[194:195], s[14:15] op_sel_hi:[1,0]
    v_pk_mul_f32 v[206:207], v[206:207], s[14:15] op_sel:[0,1] op_sel_hi:[1,1]
    s_waitcnt vmcnt(0)
    v_cmp_ne_u64 vcc, v[234:235], v[2:3]
    s_nop 2
    s_mov_b64 s[62:63], vcc
    v_cmp_ne_u64 vcc, v[238:239], v[2:3]
    s_nop 2
    s_or_b64 s[62:63], s[62:63], vcc
    v_cmp_ne_u64 vcc, v[242:243], v[2:3]
    s_nop 2
    s_or_b64 s[62:63], s[62:63], vcc
    v_cmp_ne_u64 vcc, v[246:247], v[2:3]
    s_nop 2
    s_or_b64 s[62:63], s[62:63], vcc
    v_cmp_ne_u64 vcc, v[250:251], v[2:3]
    s_nop 2
    s_or_b64 s[62:63], s[62:63], vcc
    v_cmp_ne_u64 vcc, v[254:255], v[2:3]
    s_nop 2
    s_or_b64 s[62:63], s[62:63], vcc
    s_cbranch_scc0 L_gok_7
    s_mov_b32 s88, 0
L_gsp_8:
    buffer_load_dwordx4 v[232:235], v1, s[48:51], s94 offen offset:0 sc1
    buffer_load_dwordx4 v[236:239], v1, s[48:51], s95 offen offset:0 sc1
    buffer_load_dwordx4 v[240:243], v1, s[48:51], s94 offen offset:1024 sc1
    buffer_load_dwordx4 v[244:247], v1, s[48:51], s95 offen offset:1024 sc1
    buffer_load_dwordx4 v[248:251], v1, s[48:51], s94 offen offset:2048 sc1
    buffer_load_dwordx4 v[252:255], v1, s[48:51], s95 offen offset:2048 sc1
    s_waitcnt vmcnt(0)
    v_cmp_ne_u64 vcc, v[234:235], v[2:3]
    s_nop 2
    s_mov_b64 s[62:63], vcc
    v_cmp_ne_u64 vcc, v[238:239], v[2:3]
    s_nop 2
    s_or_b64 s[62:63], s[62:63], vcc
    v_cmp_ne_u64 vcc, v[242:243], v[2:3]
    s_nop 2
    s_or_b64 s[62:63], s[62:63], vcc
    v_cmp_ne_u64 vcc, v[246:247], v[2:3]
    s_nop 2
    s_or_b64 s[62:63], s[62:63], vcc
    v_cmp_ne_u64 vcc, v[250:251], v[2:3]
    s_nop 2
    s_or_b64 s[62:63], s[62:63], vcc
    v_cmp_ne_u64 vcc, v[254:255], v[2:3]
    s_nop 2
    s_or_b64 s[62:63], s[62:63], vcc
    s_cbranch_scc0 L_gok_7
    s_add_u32 s88, s88, 1
    s_cmp_lt_u32 s88, 262144
    s_cbranch_scc1 L_gsp_8
L_gok_7:
    s_cmp_ge_u32 s3, 2
    s_cselect_b32 s62, 1.0, 0
    s_mul_i32 s57, s3, 1536
    s_add_u32 s57, s57, 155648
    v_lshl_add_u32 v12, v0, 3, s57
    v_pk_add_f32 v[232:233], v[232:233], v[236:237]
    v_pk_add_f32 v[240:241], v[240:241], v[244:245]
    v_pk_add_f32 v[248:249], v[248:249], v[252:253]
    v_pk_add_f32 v[232:233], v[232:233], s[62:63] op_sel_hi:[1,0]
    v_pk_add_f32 v[240:241], v[240:241], s[62:63] op_sel_hi:[1,0]
    v_pk_add_f32 v[248:249], v[248:249], s[62:63] op_sel_hi:[1,0]
    ds_write_b64 v12, v[232:233] offset:0
    ds_write_b64 v12, v[240:241] offset:512
    ds_write_b64 v12, v[248:249] offset:1024
    v_add_u32 v12, 155648, v1
    s_waitcnt lgkmcnt(0)
    s_barrier
    ds_read_b128 v[220:223], v12 offset:0
    ds_read_b128 v[224:227], v12 offset:1024
    ds_read_b128 v[228:231], v12 offset:2048
    ds_read_b128 v[208:211], v12 offset:3072
    ds_read_b128 v[212:215], v12 offset:4096
    ds_read_b128 v[216:219], v12 offset:5120
    s_waitcnt lgkmcnt(0)
    v_pk_fma_f32 v[112:113], v[112:113], v[208:209], v[220:221]
    v_pk_fma_f32 v[114:115], v[114:115], v[210:211], v[222:223]
    v_pk_fma_f32 v[116:117], v[116:117], v[212:213], v[224:225]
    v_pk_fma_f32 v[118:119], v[118:119], v[214:215], v[226:227]
    v_pk_fma_f32 v[120:121], v[120:121], v[216:217], v[228:229]
    v_pk_fma_f32 v[122:123], v[122:123], v[218:219], v[230:231]
    v_cvt_pk_bf16_f32 v64, v112, v113
    v_cvt_pk_bf16_f32 v65, v114, v115
    v_cvt_pk_bf16_f32 v66, v116, v117
    v_cvt_pk_bf16_f32 v67, v118, v119
    v_cvt_pk_bf16_f32 v68, v120, v121
    v_cvt_pk_bf16_f32 v69, v122, v123
    ds_write_b64 v48, v[64:65] offset:0
    ds_write_b64 v48, v[66:67] offset:4096
    ds_write_b64 v48, v[68:69] offset:8192
    v_pk_fma_f32 v[124:125], v[124:125], v[208:209], v[220:221]
    v_pk_fma_f32 v[126:127], v[126:127], v[210:211], v[222:223]
    v_pk_fma_f32 v[128:129], v[128:129], v[212:213], v[224:225]
    v_pk_fma_f32 v[130:131], v[130:131], v[214:215], v[226:227]
    v_pk_fma_f32 v[132:133], v[132:133], v[216:217], v[228:229]
    v_pk_fma_f32 v[134:135], v[134:135], v[218:219], v[230:231]
    v_cvt_pk_bf16_f32 v70, v124, v125
    v_cvt_pk_bf16_f32 v71, v126, v127
    v_cvt_pk_bf16_f32 v72, v128, v129
    v_cvt_pk_bf16_f32 v73, v130, v131
    v_cvt_pk_bf16_f32 v74, v132, v133
    v_cvt_pk_bf16_f32 v75, v134, v135
    ds_write_b64 v49, v[70:71] offset:0
    ds_write_b64 v49, v[72:73] offset:4096
    ds_write_b64 v49, v[74:75] offset:8192
    v_pk_fma_f32 v[136:137], v[136:137], v[208:209], v[220:221]
    v_pk_fma_f32 v[138:139], v[138:139], v[210:211], v[222:223]
    v_pk_fma_f32 v[140:141], v[140:141], v[212:213], v[224:225]
    v_pk_fma_f32 v[142:143], v[142:143], v[214:215], v[226:227]
    v_pk_fma_f32 v[144:145], v[144:145], v[216:217], v[228:229]
    v_pk_fma_f32 v[146:147], v[146:147], v[218:219], v[230:231]
    v_cvt_pk_bf16_f32 v76, v136, v137
    v_cvt_pk_bf16_f32 v77, v138, v139
    v_cvt_pk_bf16_f32 v78, v140, v141
    v_cvt_pk_bf16_f32 v79, v142, v143
    v_cvt_pk_bf16_f32 v80, v144, v145
    v_cvt_pk_bf16_f32 v81, v146, v147
    ds_write_b64 v50, v[76:77] offset:0
    ds_write_b64 v50, v[78:79] offset:4096
    ds_write_b64 v50, v[80:81] offset:8192
    v_pk_fma_f32 v[148:149], v[148:149], v[208:209], v[220:221]
    v_pk_fma_f32 v[150:151], v[150:151], v[210:211], v[222:223]
    v_pk_fma_f32 v[152:153], v[152:153], v[212:213], v[224:225]
    v_pk_fma_f32 v[154:155], v[154:155], v[214:215], v[226:227]
    v_pk_fma_f32 v[156:157], v[156:157], v[216:217], v[228:229]
    v_pk_fma_f32 v[158:159], v[158:159], v[218:219], v[230:231]
    v_cvt_pk_bf16_f32 v82, v148, v149
    v_cvt_pk_bf16_f32 v83, v150, v151
    v_cvt_pk_bf16_f32 v84, v152, v153
    v_cvt_pk_bf16_f32 v85, v154, v155
    v_cvt_pk_bf16_f32 v86, v156, v157
    v_cvt_pk_bf16_f32 v87, v158, v159
    ds_write_b64 v51, v[82:83] offset:0
    ds_write_b64 v51, v[84:85] offset:4096
    ds_write_b64 v51, v[86:87] offset:8192
    v_pk_fma_f32 v[160:161], v[160:161], v[208:209], v[220:221]
    v_pk_fma_f32 v[162:163], v[162:163], v[210:211], v[222:223]
    v_pk_fma_f32 v[164:165], v[164:165], v[212:213], v[224:225]
    v_pk_fma_f32 v[166:167], v[166:167], v[214:215], v[226:227]
    v_pk_fma_f32 v[168:169], v[168:169], v[216:217], v[228:229]
    v_pk_fma_f32 v[170:171], v[170:171], v[218:219], v[230:231]
    v_cvt_pk_bf16_f32 v88, v160, v161
    v_cvt_pk_bf16_f32 v89, v162, v163
    v_cvt_pk_bf16_f32 v90, v164, v165
    v_cvt_pk_bf16_f32 v91, v166, v167
    v_cvt_pk_bf16_f32 v92, v168, v169
    v_cvt_pk_bf16_f32 v93, v170, v171
    ds_write_b64 v52, v[88:89] offset:0
    ds_write_b64 v52, v[90:91] offset:4096
    ds_write_b64 v52, v[92:93] offset:8192
    v_pk_fma_f32 v[172:173], v[172:173], v[208:209], v[220:221]
    v_pk_fma_f32 v[174:175], v[174:175], v[210:211], v[222:223]
    v_pk_fma_f32 v[176:177], v[176:177], v[212:213], v[224:225]
    v_pk_fma_f32 v[178:179], v[178:179], v[214:215], v[226:227]
    v_pk_fma_f32 v[180:181], v[180:181], v[216:217], v[228:229]
    v_pk_fma_f32 v[182:183], v[182:183], v[218:219], v[230:231]
    v_cvt_pk_bf16_f32 v94, v172, v173
    v_cvt_pk_bf16_f32 v95, v174, v175
    v_cvt_pk_bf16_f32 v96, v176, v177
    v_cvt_pk_bf16_f32 v97, v178, v179
    v_cvt_pk_bf16_f32 v98, v180, v181
    v_cvt_pk_bf16_f32 v99, v182, v183
    ds_write_b64 v53, v[94:95] offset:0
    ds_write_b64 v53, v[96:97] offset:4096
    ds_write_b64 v53, v[98:99] offset:8192
    v_pk_fma_f32 v[184:185], v[184:185], v[208:209], v[220:221]
    v_pk_fma_f32 v[186:187], v[186:187], v[210:211], v[222:223]
    v_pk_fma_f32 v[188:189], v[188:189], v[212:213], v[224:225]
    v_pk_fma_f32 v[190:191], v[190:191], v[214:215], v[226:227]
    v_pk_fma_f32 v[192:193], v[192:193], v[216:217], v[228:229]
    v_pk_fma_f32 v[194:195], v[194:195], v[218:219], v[230:231]
    v_cvt_pk_bf16_f32 v100, v184, v185
    v_cvt_pk_bf16_f32 v101, v186, v187
    v_cvt_pk_bf16_f32 v102, v188, v189
    v_cvt_pk_bf16_f32 v103, v190, v191
    v_cvt_pk_bf16_f32 v104, v192, v193
    v_cvt_pk_bf16_f32 v105, v194, v195
    ds_write_b64 v54, v[100:101] offset:0
    ds_write_b64 v54, v[102:103] offset:4096
    ds_write_b64 v54, v[104:105] offset:8192
    v_pk_fma_f32 v[196:197], v[196:197], v[208:209], v[220:221]
    v_pk_fma_f32 v[198:199], v[198:199], v[210:211], v[222:223]
    v_pk_fma_f32 v[200:201], v[200:201], v[212:213], v[224:225]
    v_pk_fma_f32 v[202:203], v[202:203], v[214:215], v[226:227]
    v_pk_fma_f32 v[204:205], v[204:205], v[216:217], v[228:229]
    v_pk_fma_f32 v[206:207], v[206:207], v[218:219], v[230:231]
    v_cvt_pk_bf16_f32 v106, v196, v197
    v_cvt_pk_bf16_f32 v107, v198, v199
    v_cvt_pk_bf16_f32 v108, v200, v201
    v_cvt_pk_bf16_f32 v109, v202, v203
    v_cvt_pk_bf16_f32 v110, v204, v205
    v_cvt_pk_bf16_f32 v111, v206, v207
    ds_write_b64 v55, v[106:107] offset:0
    ds_write_b64 v55, v[108:109] offset:4096
    ds_write_b64 v55, v[110:111] offset:8192
    s_waitcnt lgkmcnt(0)
    ds_read_b128 v[112:115], v56 offset:0
    ds_read_b128 v[116:119], v56 offset:1024
    ds_read_b128 v[120:123], v56 offset:2048
    ds_read_b128 v[124:127], v56 offset:3072
    ds_read_b128 v[128:131], v56 offset:4096
    ds_read_b128 v[132:135], v56 offset:5120
    ds_read_b128 v[136:139], v56 offset:6144
    ds_read_b128 v[140:143], v56 offset:7168
    ds_read_b128 v[144:147], v56 offset:8192
    ds_read_b128 v[148:151], v56 offset:9216
    ds_read_b128 v[152:155], v56 offset:10240
    ds_read_b128 v[156:159], v56 offset:11264
    s_waitcnt lgkmcnt(11)
    buffer_store_dwordx4 v[112:115], v57, s[48:51], s68 offen sc1
    s_add_u32 s68, s68, 4096
    s_waitcnt lgkmcnt(10)
    buffer_store_dwordx4 v[116:119], v57, s[48:51], s68 offen sc1
    s_add_u32 s68, s68, 4096
    s_waitcnt lgkmcnt(9)
    buffer_store_dwordx4 v[120:123], v57, s[48:51], s68 offen sc1
    s_add_u32 s68, s68, 4096
    s_waitcnt lgkmcnt(8)
    buffer_store_dwordx4 v[124:127], v57, s[48:51], s68 offen sc1
    s_add_u32 s68, s68, 4096
    s_waitcnt lgkmcnt(7)
    buffer_store_dwordx4 v[128:131], v57, s[48:51], s68 offen sc1
    s_add_u32 s68, s68, 4096
    s_waitcnt lgkmcnt(6)
    buffer_store_dwordx4 v[132:135], v57, s[48:51], s68 offen sc1
    s_add_u32 s68, s68, 4096
    s_waitcnt lgkmcnt(5)
    buffer_store_dwordx4 v[136:139], v57, s[48:51], s68 offen sc1
    s_add_u32 s68, s68, 4096
    s_waitcnt lgkmcnt(4)
    buffer_store_dwordx4 v[140:143], v57, s[48:51], s68 offen sc1
    s_add_u32 s68, s68, 4096
    s_waitcnt lgkmcnt(3)
    buffer_store_dwordx4 v[144:147], v57, s[48:51], s68 offen sc1
    s_add_u32 s68, s68, 4096
    s_waitcnt lgkmcnt(2)
    buffer_store_dwordx4 v[148:151], v57, s[48:51], s68 offen sc1
    s_add_u32 s68, s68, 4096
    s_waitcnt lgkmcnt(1)
    buffer_store_dwordx4 v[152:155], v57, s[48:51], s68 offen sc1
    s_add_u32 s68, s68, 4096
    s_waitcnt lgkmcnt(0)
    buffer_store_dwordx4 v[156:159], v57, s[48:51], s68 offen sc1
    s_lshl_b32 s57, s64, 7
    s_lshl_b32 s58, s3, 3
    s_add_u32 s57, s57, s58
    s_add_u32 s89, s57, 19529728
    s_mov_b32 s90, 0
    s_barrier
    s_branch L_A_done
L_A_gemm:
    s_sub_u32 s28, s8, 4096
    s_subb_u32 s29, s9, 0
    s_mov_b32 s30, 3543040
    s_mov_b32 s31, 0x20000
    s_cmp_ge_u32 s52, 4
    s_cbranch_scc1 L_A_w
    s_lshr_b32 s57, s52, 0
    s_and_b32 s57, s57, 1
    s_xor_b32 s57, s57, 1
    s_lshl_b32 s57, s57, 2
    s_and_b32 s58, s53, 3
    s_add_u32 s64, s58, s57
    s_lshr_b32 s57, s52, 1
    s_and_b32 s57, s57, 1
    s_mul_i32 s57, s57, 6
    s_lshr_b32 s62, s53, 2
    s_add_u32 s65, s62, s57
    s_mul_i32 s58, s58, 3
    s_lshl_b32 s62, s62, 1
    s_add_u32 s59, s58, s62
    s_cmp_ge_u32 s59, 12
    s_cselect_b32 s58, 12, 0
    s_sub_u32 s59, s59, s58
    s_and_b32 s94, s3, 1
    s_lshr_b32 s95, s3, 1
    v_lshrrev_b32 v9, 3, v0
    v_and_b32 v10, 7, v0
    v_lshrrev_b32 v11, 4, v0
    v_mul_u32_u24 v12, 4608, v9
    v_xor_b32 v13, v10, v11
    v_xor_b32 v14, 4, v13
    v_lshl_add_u32 v13, v13, 4, v12
    v_lshl_add_u32 v14, v14, 4, v12
    s_mul_i32 s60, s65, 294912
    s_mul_i32 s57, s3, 73728
    s_add_u32 s60, s60, s57
    s_add_u32 s60, s60, 4096
    v_add_u32 v4, s60, v13
    s_add_u32 s57, s60, 35840
    v_add_u32 v5, s57, v14
    s_mul_i32 s61, s64, 442368
    s_mul_i32 s57, s3, 110592
    s_add_u32 s61, s61, s57
    s_add_u32 s61, s61, 5632
    s_cmp_eq_u32 s94, 0
    s_cselect_b64 vcc, -1, 0
    v_cndmask_b32 v15, v14, v13, vcc
    v_cndmask_b32 v9, v13, v14, vcc
    v_add_u32 v6, s61, v15
    s_add_u32 s57, s61, 35840
    v_add_u32 v7, s57, v9
    s_add_u32 s57, s61, 71680
    v_add_u32 v8, s57, v15
    s_lshl_b32 s66, s3, 11
    s_mul_i32 s67, s3, 3072
    s_add_u32 s67, s67, 8192
    s_lshl_b32 s68, s59, 7
    s_add_u32 m0, s66, 0
    s_nop 0
    buffer_load_dwordx4 v4, s[28:31], s68 offen lds
    buffer_load_dwordx4 v5, s[28:31], s68 offen offset:1024 lds
    s_add_u32 m0, s67, 0
    s_nop 0
    buffer_load_dwordx4 v6, s[28:31], s68 offen offset:0 lds
    buffer_load_dwordx4 v7, s[28:31], s68 offen offset:1024 lds
    buffer_load_dwordx4 v8, s[28:31], s68 offen offset:2048 lds
    s_add_u32 s59, s59, 1
    s_cmp_eq_u32 s59, 12
    s_cselect_b32 s59, 0, s59
    s_lshl_b32 s68, s59, 7
    s_add_u32 m0, s66, 20480
    s_nop 0
    buffer_load_dwordx4 v4, s[28:31], s68 offen lds
    buffer_load_dwordx4 v5, s[28:31], s68 offen offset:1024 lds
    s_add_u32 m0, s67, 20480
    s_nop 0
    buffer_load_dwordx4 v6, s[28:31], s68 offen offset:0 lds
    buffer_load_dwordx4 v7, s[28:31], s68 offen offset:1024 lds
    buffer_load_dwordx4 v8, s[28:31], s68 offen offset:2048 lds
    s_add_u32 s59, s59, 1
    s_cmp_eq_u32 s59, 12
    s_cselect_b32 s59, 0, s59
    s_lshl_b32 s68, s59, 7
    s_add_u32 m0, s66, 40960
    s_nop 0
    buffer_load_dwordx4 v4, s[28:31], s68 offen lds
    buffer_load_dwordx4 v5, s[28:31], s68 offen offset:1024 lds
    s_add_u32 m0, s67, 40960
    s_nop 0
    buffer_load_dwordx4 v6, s[28:31], s68 offen offset:0 lds
    buffer_load_dwordx4 v7, s[28:31], s68 offen offset:1024 lds
    buffer_load_dwordx4 v8, s[28:31], s68 offen offset:2048 lds
    s_add_u32 s59, s59, 1
    s_cmp_eq_u32 s59, 12
    s_cselect_b32 s59, 0, s59
    s_lshr_b32 s57, s52, 1
    s_lshl_b32 s57, s57, 2
    s_and_b32 s58, s53, 3
    s_add_u32 s54, s57, s58
    s_and_b32 s57, s52, 1
    s_lshl_b32 s57, s57, 3
    s_lshr_b32 s58, s53, 2
    s_add_u32 s55, s57, s58
    v_and_b32 v20, 31, v0
    v_lshrrev_b32 v21, 5, v0
    v_lshrrev_b32 v22, 1, v20
    v_and_b32 v22, 7, v22
    s_lshl_b32 s57, s95, 2
    v_add_u32 v23, s57, v21
    v_add_u32 v24, 0, v23
    v_xor_b32 v24, v24, v22
    v_lshlrev_b32 v24, 4, v24
    v_lshl_add_u32 v24, v20, 7, v24
    s_lshl_b32 s57, s94, 12
    v_add_u32 v100, s57, v24
    v_add_u32 v101, 61440, v100
    v_add_u32 v102, 122880, v100
    v_add_u32 v106, 8192, v24
    v_add_u32 v107, 69632, v24
    v_add_u32 v108, 131072, v24
    v_add_u32 v24, 2, v23
    v_xor_b32 v24, v24, v22
    v_lshlrev_b32 v24, 4, v24
    v_lshl_add_u32 v24, v20, 7, v24
    s_lshl_b32 s57, s94, 12
    v_add_u32 v103, s57, v24
    v_add_u32 v104, 61440, v103
    v_add_u32 v105, 122880, v103
    v_add_u32 v109, 8192, v24
    v_add_u32 v110, 69632, v24
    v_add_u32 v111, 131072, v24
    s_waitcnt vmcnt(10)
    s_barrier
    ds_read_b128 a[0:3], v100 offset:0
    ds_read_b128 a[8:11], v106 offset:0
    ds_read_b128 a[12:15], v106 offset:4096
    ds_read_b128 a[16:19], v106 offset:8192
    ds_read_b128 a[4:7], v103 offset:0
    ds_read_b128 a[20:23], v109 offset:0
    ds_read_b128 a[24:27], v109 offset:4096
    ds_read_b128 a[28:31], v109 offset:8192
    s_waitcnt vmcnt(5)
    s_barrier
    s_waitcnt lgkmcnt(4)
    v_mfma_f32_32x32x16_bf16 v[16:31], a[0:3], a[8:11], 0
    ds_read_b128 a[32:35], v100 offset:20480
    ds_read_b128 a[40:43], v106 offset:20480
    ds_read_b128 a[44:47], v106 offset:24576
    ds_read_b128 a[48:51], v106 offset:28672
    s_lshl_b32 s68, s59, 7
    s_add_u32 m0, s66, 61440
    s_nop 0
    buffer_load_dwordx4 v4, s[28:31], s68 offen lds
    buffer_load_dwordx4 v5, s[28:31], s68 offen offset:1024 lds
    v_mfma_f32_32x32x16_bf16 v[32:47], a[0:3], a[12:15], 0
    ds_read_b128 a[36:39], v103 offset:20480
    ds_read_b128 a[52:55], v109 offset:20480
    ds_read_b128 a[56:59], v109 offset:24576
    ds_read_b128 a[60:63], v109 offset:28672
    s_add_u32 m0, s67, 61440
    s_nop 0
    buffer_load_dwordx4 v6, s[28:31], s68 offen offset:0 lds
    buffer_load_dwordx4 v7, s[28:31], s68 offen offset:1024 lds
    v_mfma_f32_32x32x16_bf16 v[48:63], a[0:3], a[16:19], 0
    buffer_load_dwordx4 v8, s[28:31], s68 offen offset:2048 lds
    s_add_u32 s59, s59, 1
    s_cmp_eq_u32 s59, 12
    s_cselect_b32 s59, 0, s59
    s_lshl_b32 s68, s59, 7
    s_add_u32 m0, s66, 81920
    s_nop 0
    buffer_load_dwordx4 v4, s[28:31], s68 offen lds
    s_waitcnt lgkmcnt(8)
    v_mfma_f32_32x32x16_bf16 v[16:31], a[4:7], a[20:23], v[16:31]
    buffer_load_dwordx4 v5, s[28:31], s68 offen offset:1024 lds
    s_add_u32 m0, s67, 81920
    s_nop 0
    buffer_load_dwordx4 v6, s[28:31], s68 offen offset:0 lds
    v_mfma_f32_32x32x16_bf16 v[32:47], a[4:7], a[24:27], v[32:47]
    buffer_load_dwordx4 v7, s[28:31], s68 offen offset:1024 lds
    buffer_load_dwordx4 v8, s[28:31], s68 offen offset:2048 lds
    s_add_u32 s59, s59, 1
    s_cmp_eq_u32 s59, 12
    s_cselect_b32 s59, 0, s59
    v_mfma_f32_32x32x16_bf16 v[48:63], a[4:7], a[28:31], v[48:63]
    s_waitcnt vmcnt(10)
    s_barrier
    s_waitcnt lgkmcnt(4)
    v_mfma_f32_32x32x16_bf16 v[16:31], a[32:35], a[40:43], v[16:31]
    ds_read_b128 a[0:3], v100 offset:40960
    ds_read_b128 a[8:11], v106 offset:40960
    ds_read_b128 a[12:15], v106 offset:45056
    ds_read_b128 a[16:19], v106 offset:49152
    s_lshl_b32 s68, s59, 7
    s_add_u32 m0, s66, 102400
    s_nop 0
    buffer_load_dwordx4 v4, s[28:31], s68 offen lds
    v_mfma_f32_32x32x16_bf16 v[32:47], a[32:35], a[44:47], v[32:47]
    ds_read_b128 a[4:7], v103 offset:40960
    ds_read_b128 a[20:23], v109 offset:40960
    ds_read_b128 a[24:27], v109 offset:45056
    ds_read_b128 a[28:31], v109 offset:49152
    buffer_load_dwordx4 v5, s[28:31], s68 offen offset:1024 lds
    v_mfma_f32_32x32x16_bf16 v[48:63], a[32:35], a[48:51], v[48:63]
    s_add_u32 m0, s67, 102400
    s_nop 0
    buffer_load_dwordx4 v6, s[28:31], s68 offen offset:0 lds
    s_waitcnt lgkmcnt(8)
    v_mfma_f32_32x32x16_bf16 v[16:31], a[36:39], a[52:55], v[16:31]
    buffer_load_dwordx4 v7, s[28:31], s68 offen offset:1024 lds
    v_mfma_f32_32x32x16_bf16 v[32:47], a[36:39], a[56:59], v[32:47]
    buffer_load_dwordx4 v8, s[28:31], s68 offen offset:2048 lds
    s_add_u32 s59, s59, 1
    s_cmp_eq_u32 s59, 12
    s_cselect_b32 s59, 0, s59
    v_mfma_f32_32x32x16_bf16 v[48:63], a[36:39], a[60:63], v[48:63]
    s_waitcnt vmcnt(10)
    s_barrier
    s_waitcnt lgkmcnt(4)
    v_mfma_f32_32x32x16_bf16 v[16:31], a[0:3], a[8:11], v[16:31]
    ds_read_b128 a[32:35], v101 offset:0
    ds_read_b128 a[40:43], v107 offset:0
    ds_read_b128 a[44:47], v107 offset:4096
    ds_read_b128 a[48:51], v107 offset:8192
    s_lshl_b32 s68, s59, 7
    s_add_u32 m0, s66, 122880
    s_nop 0
    buffer_load_dwordx4 v4, s[28:31], s68 offen lds
    buffer_load_dwordx4 v5, s[28:31], s68 offen offset:1024 lds
    v_mfma_f32_32x32x16_bf16 v[32:47], a[0:3], a[12:15], v[32:47]
    ds_read_b128 a[36:39], v104 offset:0
    ds_read_b128 a[52:55], v110 offset:0
    ds_read_b128 a[56:59], v110 offset:4096
    ds_read_b128 a[60:63], v110 offset:8192
    s_add_u32 m0, s67, 122880
    s_nop 0
    buffer_load_dwordx4 v6, s[28:31], s68 offen offset:0 lds
    buffer_load_dwordx4 v7, s[28:31], s68 offen offset:1024 lds
    v_mfma_f32_32x32x16_bf16 v[48:63], a[0:3], a[16:19], v[48:63]
    buffer_load_dwordx4 v8, s[28:31], s68 offen offset:2048 lds
    s_add_u32 s59, s59, 1
    s_cmp_eq_u32 s59, 12
    s_cselect_b32 s59, 0, s59
    s_lshl_b32 s68, s59, 7
    s_add_u32 m0, s66, 143360
    s_nop 0
    buffer_load_dwordx4 v4, s[28:31], s68 offen lds
    s_waitcnt lgkmcnt(8)
    v_mfma_f32_32x32x16_bf16 v[16:31], a[4:7], a[20:23], v[16:31]
    buffer_load_dwordx4 v5, s[28:31], s68 offen offset:1024 lds
    s_add_u32 m0, s67, 143360
    s_nop 0
    buffer_load_dwordx4 v6, s[28:31], s68 offen offset:0 lds
    v_mfma_f32_32x32x16_bf16 v[32:47], a[4:7], a[24:27], v[32:47]
    buffer_load_dwordx4 v7, s[28:31], s68 offen offset:1024 lds
    buffer_load_dwordx4 v8, s[28:31], s68 offen offset:2048 lds
    s_add_u32 s59, s59, 1
    s_cmp_eq_u32 s59, 12
    s_cselect_b32 s59, 0, s59
    v_mfma_f32_32x32x16_bf16 v[48:63], a[4:7], a[28:31], v[48:63]
    s_waitcnt vmcnt(15)
    s_barrier
    s_waitcnt lgkmcnt(4)
    v_mfma_f32_32x32x16_bf16 v[16:31], a[32:35], a[40:43], v[16:31]
    ds_read_b128 a[0:3], v101 offset:20480
    ds_read_b128 a[8:11], v107 offset:20480
    ds_read_b128 a[12:15], v107 offset:24576
    ds_read_b128 a[16:19], v107 offset:28672
    s_lshl_b32 s68, s59, 7
    s_add_u32 m0, s66, 0
    s_nop 0
    buffer_load_dwordx4 v4, s[28:31], s68 offen lds
    v_mfma_f32_32x32x16_bf16 v[32:47], a[32:35], a[44:47], v[32:47]
    ds_read_b128 a[4:7], v104 offset:20480
    ds_read_b128 a[20:23], v110 offset:20480
    ds_read_b128 a[24:27], v110 offset:24576
    ds_read_b128 a[28:31], v110 offset:28672
    buffer_load_dwordx4 v5, s[28:31], s68 offen offset:1024 lds
    v_mfma_f32_32x32x16_bf16 v[48:63], a[32:35], a[48:51], v[48:63]
    s_add_u32 m0, s67, 0
    s_nop 0
    buffer_load_dwordx4 v6, s[28:31], s68 offen offset:0 lds
    s_waitcnt lgkmcnt(8)
    v_mfma_f32_32x32x16_bf16 v[16:31], a[36:39], a[52:55], v[16:31]
    buffer_load_dwordx4 v7, s[28:31], s68 offen offset:1024 lds
    v_mfma_f32_32x32x16_bf16 v[32:47], a[36:39], a[56:59], v[32:47]
    buffer_load_dwordx4 v8, s[28:31], s68 offen offset:2048 lds
    s_add_u32 s59, s59, 1
    s_cmp_eq_u32 s59, 12
    s_cselect_b32 s59, 0, s59
    v_mfma_f32_32x32x16_bf16 v[48:63], a[36:39], a[60:63], v[48:63]
    s_waitcnt vmcnt(15)
    s_barrier
    s_waitcnt lgkmcnt(4)
    v_mfma_f32_32x32x16_bf16 v[16:31], a[0:3], a[8:11], v[16:31]
    ds_read_b128 a[32:35], v101 offset:40960
    ds_read_b128 a[40:43], v107 offset:40960
    ds_read_b128 a[44:47], v107 offset:45056
    ds_read_b128 a[48:51], v107 offset:49152
    s_lshl_b32 s68, s59, 7
    s_add_u32 m0, s66, 20480
    s_nop 0
    buffer_load_dwordx4 v4, s[28:31], s68 offen lds
    v_mfma_f32_32x32x16_bf16 v[32:47], a[0:3], a[12:15], v[32:47]
    ds_read_b128 a[36:39], v104 offset:40960
    ds_read_b128 a[52:55], v110 offset:40960
    ds_read_b128 a[56:59], v110 offset:45056
    ds_read_b128 a[60:63], v110 offset:49152
    buffer_load_dwordx4 v5, s[28:31], s68 offen offset:1024 lds
    v_mfma_f32_32x32x16_bf16 v[48:63], a[0:3], a[16:19], v[48:63]
    s_add_u32 m0, s67, 20480
    s_nop 0
    buffer_load_dwordx4 v6, s[28:31], s68 offen offset:0 lds
    s_waitcnt lgkmcnt(8)
    v_mfma_f32_32x32x16_bf16 v[16:31], a[4:7], a[20:23], v[16:31]
    buffer_load_dwordx4 v7, s[28:31], s68 offen offset:1024 lds
    v_mfma_f32_32x32x16_bf16 v[32:47], a[4:7], a[24:27], v[32:47]
    buffer_load_dwordx4 v8, s[28:31], s68 offen offset:2048 lds
    s_add_u32 s59, s59, 1
    s_cmp_eq_u32 s59, 12
    s_cselect_b32 s59, 0, s59
    v_mfma_f32_32x32x16_bf16 v[48:63], a[4:7], a[28:31], v[48:63]
    s_waitcnt vmcnt(15)
    s_barrier
    s_waitcnt lgkmcnt(4)
    v_mfma_f32_32x32x16_bf16 v[16:31], a[32:35], a[40:43], v[16:31]
    ds_read_b128 a[0:3], v102 offset:0
    ds_read_b128 a[8:11], v108 offset:0
    ds_read_b128 a[12:15], v108 offset:4096
    ds_read_b128 a[16:19], v108 offset:8192
    s_lshl_b32 s68, s59, 7
    s_add_u32 m0, s66, 40960
    s_nop 0
    buffer_load_dwordx4 v4, s[28:31], s68 offen lds
    v_mfma_f32_32x32x16_bf16 v[32:47], a[32:35], a[44:47], v[32:47]
    ds_read_b128 a[4:7], v105 offset:0
    ds_read_b128 a[20:23], v111 offset:0
    ds_read_b128 a[24:27], v111 offset:4096
    ds_read_b128 a[28:31], v111 offset:8192
    buffer_load_dwordx4 v5, s[28:31], s68 offen offset:1024 lds
    v_mfma_f32_32x32x16_bf16 v[48:63], a[32:35], a[48:51], v[48:63]
    s_add_u32 m0, s67, 40960
    s_nop 0
    buffer_load_dwordx4 v6, s[28:31], s68 offen offset:0 lds
    s_waitcnt lgkmcnt(8)
    v_mfma_f32_32x32x16_bf16 v[16:31], a[36:39], a[52:55], v[16:31]
    buffer_load_dwordx4 v7, s[28:31], s68 offen offset:1024 lds
    v_mfma_f32_32x32x16_bf16 v[32:47], a[36:39], a[56:59], v[32:47]
    buffer_load_dwordx4 v8, s[28:31], s68 offen offset:2048 lds
    s_add_u32 s59, s59, 1
    s_cmp_eq_u32 s59, 12
    s_cselect_b32 s59, 0, s59
    v_mfma_f32_32x32x16_bf16 v[48:63], a[36:39], a[60:63], v[48:63]
    buffer_load_dwordx2 v[2:3], off, s[44:47], 0 sc1
    s_waitcnt vmcnt(16)
    s_barrier
    s_waitcnt lgkmcnt(4)
    v_mfma_f32_32x32x16_bf16 v[16:31], a[0:3], a[8:11], v[16:31]
    ds_read_b128 a[32:35], v102 offset:20480
    ds_read_b128 a[40:43], v108 offset:20480
    ds_read_b128 a[44:47], v108 offset:24576
    ds_read_b128 a[48:51], v108 offset:28672
    s_lshl_b32 s68, s59, 7
    s_add_u32 m0, s66, 61440
    s_nop 0
    buffer_load_dwordx4 v4, s[28:31], s68 offen lds
    v_mfma_f32_32x32x16_bf16 v[32:47], a[0:3], a[12:15], v[32:47]
    ds_read_b128 a[36:39], v105 offset:20480
    ds_read_b128 a[52:55], v111 offset:20480
    ds_read_b128 a[56:59], v111 offset:24576
    ds_read_b128 a[60:63], v111 offset:28672
    buffer_load_dwordx4 v5, s[28:31], s68 offen offset:1024 lds
    v_mfma_f32_32x32x16_bf16 v[48:63], a[0:3], a[16:19], v[48:63]
    s_add_u32 m0, s67, 61440
    s_nop 0
    buffer_load_dwordx4 v6, s[28:31], s68 offen offset:0 lds
    s_waitcnt lgkmcnt(8)
    v_mfma_f32_32x32x16_bf16 v[16:31], a[4:7], a[20:23], v[16:31]
    buffer_load_dwordx4 v7, s[28:31], s68 offen offset:1024 lds
    v_mfma_f32_32x32x16_bf16 v[32:47], a[4:7], a[24:27], v[32:47]
    buffer_load_dwordx4 v8, s[28:31], s68 offen offset:2048 lds
    s_add_u32 s59, s59, 1
    s_cmp_eq_u32 s59, 12
    s_cselect_b32 s59, 0, s59
    v_mfma_f32_32x32x16_bf16 v[48:63], a[4:7], a[28:31], v[48:63]
    s_waitcnt vmcnt(16)
    s_barrier
    s_waitcnt lgkmcnt(4)
    v_mfma_f32_32x32x16_bf16 v[16:31], a[32:35], a[40:43], v[16:31]
    ds_read_b128 a[0:3], v100 offset:0
    ds_read_b128 a[8:11], v106 offset:0
    ds_read_b128 a[12:15], v106 offset:4096
    ds_read_b128 a[16:19], v106 offset:8192
    v_mfma_f32_32x32x16_bf16 v[32:47], a[32:35], a[44:47], v[32:47]
    ds_read_b128 a[4:7], v103 offset:0
    ds_read_b128 a[20:23], v109 offset:0
    ds_read_b128 a[24:27], v109 offset:4096
    ds_read_b128 a[28:31], v109 offset:8192
    v_mfma_f32_32x32x16_bf16 v[48:63], a[32:35], a[48:51], v[48:63]
    s_waitcnt lgkmcnt(8)
    v_mfma_f32_32x32x16_bf16 v[16:31], a[36:39], a[52:55], v[16:31]
    v_mfma_f32_32x32x16_bf16 v[32:47], a[36:39], a[56:59], v[32:47]
    v_mfma_f32_32x32x16_bf16 v[48:63], a[36:39], a[60:63], v[48:63]
    s_mov_b32 s24, s6
    s_mov_b32 s25, s7
    s_mov_b32 s26, 3072
    s_mov_b32 s27, 0x20000
    s_mov_b32 s36, s12
    s_mov_b32 s37, s13
    s_mov_b32 s38, 7077888
    s_mov_b32 s39, 0x20000
    s_min_u32 s58, s53, 5
    s_mul_i32 s57, s52, 6
    s_add_u32 s57, s57, s58
    s_mul_i32 s9, s57, 43
    s_lshr_b32 s9, s9, 9
    s_mul_i32 s8, s9, 12
    s_sub_u32 s8, s57, s8
    s_mul_i32 s57, s9, 192
    s_mul_i32 s58, s3, 48
    s_add_u32 s57, s57, s58
    s_lshl_b32 s58, s57, 1
    v_lshl_add_u32 v12, v0, 2, s58
    v_lshrrev_b32 v13, 3, v0
    v_mul_u32_u24 v14, 9216, v13
    v_and_b32 v15, 7, v0
    v_lshl_add_u32 v14, v15, 4, v14
    s_mul_i32 s10, s57, 9216
    s_lshl_b32 s58, s8, 7
    s_add_u32 s10, s10, s58
    s_add_u32 s10, s10, 3072
    s_mul_i32 s11, s3, 6144
    s_add_u32 s11, s11, 81920
    s_cmp_lt_u32 s53, 6
    s_cselect_b32 s58, 0, 0x10000000
    s_add_u32 s10, s10, s58
    buffer_load_dword v112, v12, s[24:27], s58 offen offset:0
    buffer_load_dword v113, v12, s[24:27], s58 offen offset:1536
    s_add_u32 m0, s11, 0
    s_nop 0
    buffer_load_dwordx4 v14, s[36:39], s10 offen nt lds
    s_add_u32 s10, s10, 73728
    s_add_u32 m0, s11, 1024
    s_nop 0
    buffer_load_dwordx4 v14, s[36:39], s10 offen nt lds
    s_add_u32 s10, s10, 73728
    s_add_u32 m0, s11, 2048
    s_nop 0
    buffer_load_dwordx4 v14, s[36:39], s10 offen nt lds
    s_add_u32 s10, s10, 73728
    s_add_u32 m0, s11, 3072
    s_nop 0
    buffer_load_dwordx4 v14, s[36:39], s10 offen nt lds
    s_add_u32 s10, s10, 73728
    s_add_u32 m0, s11, 4096
    s_nop 0
    buffer_load_dwordx4 v14, s[36:39], s10 offen nt lds
    s_add_u32 s10, s10, 73728
    s_add_u32 m0, s11, 5120
    s_nop 0
    buffer_load_dwordx4 v14, s[36:39], s10 offen nt lds
    s_waitcnt vmcnt(19)
    s_barrier
    s_waitcnt lgkmcnt(4)
    v_mfma_f32_32x32x16_bf16 v[16:31], a[0:3], a[8:11], v[16:31]
    ds_read_b128 a[32:35], v100 offset:20480
    ds_read_b128 a[40:43], v106 offset:20480
    ds_read_b128 a[44:47], v106 offset:24576
    ds_read_b128 a[48:51], v106 offset:28672
    v_mfma_f32_32x32x16_bf16 v[32:47], a[0:3], a[12:15], v[32:47]
    ds_read_b128 a[36:39], v103 offset:20480
    ds_read_b128 a[52:55], v109 offset:20480
    ds_read_b128 a[56:59], v109 offset:24576
    ds_read_b128 a[60:63], v109 offset:28672
    v_mfma_f32_32x32x16_bf16 v[48:63], a[0:3], a[16:19], v[48:63]
    s_waitcnt lgkmcnt(8)
    v_mfma_f32_32x32x16_bf16 v[16:31], a[4:7], a[20:23], v[16:31]
    v_mfma_f32_32x32x16_bf16 v[32:47], a[4:7], a[24:27], v[32:47]
    v_mfma_f32_32x32x16_bf16 v[48:63], a[4:7], a[28:31], v[48:63]
    s_mul_i32 s57, s3, 6144
    v_add_u32 v140, s57, v1
    s_xor_b32 s57, s3, 2
    s_mul_i32 s57, s57, 6144
    v_add_u32 v141, s57, v1
    s_lshl_b32 s60, s94, 1
    s_add_u32 s60, s60, s95
    s_mul_i32 s58, s64, 48
    s_lshl_b32 s56, s65, 2
    s_add_u32 s56, s56, s58
    s_add_u32 s56, s56, s60
    s_mul_i32 s14, s56, 3072
    s_mul_i32 s60, s60, 12
    s_add_u32 s60, s60, s65
    s_lshl_b32 s57, s64, 6
    s_add_u32 s57, s57, s60
    s_lshl_b32 s57, s57, 3
    s_add_u32 s89, s57, 19542016
    s_mov_b32 s90, 0
    s_waitcnt vmcnt(14)
    s_barrier
    s_waitcnt lgkmcnt(4)
    v_mfma_f32_32x32x16_bf16 v[16:31], a[32:35], a[40:43], v[16:31]
    ds_read_b128 a[0:3], v100 offset:40960
    ds_read_b128 a[8:11], v106 offset:40960
    ds_read_b128 a[12:15], v106 offset:45056
    ds_read_b128 a[16:19], v106 offset:49152
    v_mfma_f32_32x32x16_bf16 v[32:47], a[32:35], a[44:47], v[32:47]
    ds_read_b128 a[4:7], v103 offset:40960
    ds_read_b128 a[20:23], v109 offset:40960
    ds_read_b128 a[24:27], v109 offset:45056
    ds_read_b128 a[28:31], v109 offset:49152
    v_mfma_f32_32x32x16_bf16 v[48:63], a[32:35], a[48:51], v[48:63]
    s_waitcnt lgkmcnt(8)
    v_mfma_f32_32x32x16_bf16 v[16:31], a[36:39], a[52:55], v[16:31]
    v_mfma_f32_32x32x16_bf16 v[32:47], a[36:39], a[56:59], v[32:47]
    v_mfma_f32_32x32x16_bf16 v[48:63], a[36:39], a[60:63], v[48:63]
    s_waitcnt vmcnt(8)
    s_barrier
    s_waitcnt lgkmcnt(4)
    v_mfma_f32_32x32x16_bf16 v[16:31], a[0:3], a[8:11], v[16:31]
    ds_read_b128 a[32:35], v101 offset:0
    ds_read_b128 a[40:43], v107 offset:0
    ds_read_b128 a[44:47], v107 offset:4096
    ds_read_b128 a[48:51], v107 offset:8192
    v_mfma_f32_32x32x16_bf16 v[32:47], a[0:3], a[12:15], v[32:47]
    ds_read_b128 a[36:39], v104 offset:0
    ds_read_b128 a[52:55], v110 offset:0
    ds_read_b128 a[56:59], v110 offset:4096
    ds_read_b128 a[60:63], v110 offset:8192
    v_mfma_f32_32x32x16_bf16 v[48:63], a[0:3], a[16:19], v[48:63]
    s_waitcnt lgkmcnt(8)
    v_mfma_f32_32x32x16_bf16 v[16:31], a[4:7], a[20:23], v[16:31]
    v_mfma_f32_32x32x16_bf16 v[32:47], a[4:7], a[24:27], v[32:47]
    v_mfma_f32_32x32x16_bf16 v[48:63], a[4:7], a[28:31], v[48:63]
    v_cmp_eq_u32 vcc, 0, v2
    s_cbranch_vccz L_nok_9
    s_mov_b32 s88, 0
L_nsp_10:
    buffer_load_dwordx2 v[2:3], off, s[44:47], 0 sc1
    s_waitcnt vmcnt(0)
    v_cmp_eq_u32 vcc, 0, v2
    s_cbranch_vccz L_nok_9
    s_add_u32 s88, s88, 1
    s_cmp_lt_u32 s88, 262144
    s_cbranch_scc1 L_nsp_10
L_nok_9:
    s_waitcnt lgkmcnt(4)
    v_mfma_f32_32x32x16_bf16 v[16:31], a[32:35], a[40:43], v[16:31]
    v_mfma_f32_32x32x16_bf16 v[32:47], a[32:35], a[44:47], v[32:47]
    v_mfma_f32_32x32x16_bf16 v[48:63], a[32:35], a[48:51], v[48:63]
    s_waitcnt lgkmcnt(0)
    v_mfma_f32_32x32x16_bf16 v[16:31], a[36:39], a[52:55], v[16:31]
    v_mfma_f32_32x32x16_bf16 v[32:47], a[36:39], a[56:59], v[32:47]
    v_mfma_f32_32x32x16_bf16 v[48:63], a[36:39], a[60:63], v[48:63]
    s_lshr_b32 s57, s3, 1
    s_cmp_eq_u32 s57, 0
    s_cbranch_scc0 L_akh1_11
    s_nop 6
    ds_write_b128 v140, v[24:27] offset:0
    ds_write_b128 v140, v[28:31] offset:1024
    ds_write_b128 v140, v[40:43] offset:2048
    ds_write_b128 v140, v[44:47] offset:3072
    ds_write_b128 v140, v[56:59] offset:4096
    ds_write_b128 v140, v[60:63] offset:5120
    s_mov_b32 s62, 0x3d553b95
    s_waitcnt lgkmcnt(0)
    s_barrier
    ds_read_b128 v[64:67], v141 offset:0
    ds_read_b128 v[68:71], v141 offset:1024
    ds_read_b128 v[72:75], v141 offset:2048
    ds_read_b128 v[76:79], v141 offset:3072
    ds_read_b128 v[80:83], v141 offset:4096
    ds_read_b128 v[84:87], v141 offset:5120
    s_waitcnt lgkmcnt(4)
    v_pk_add_f32 v[64:65], v[16:17], v[64:65]
    v_pk_add_f32 v[66:67], v[18:19], v[66:67]
    v_pk_add_f32 v[68:69], v[20:21], v[68:69]
    v_pk_add_f32 v[70:71], v[22:23], v[70:71]
    v_pk_mul_f32 v[64:65], v[64:65], s[62:63] op_sel_hi:[1,0]
    v_pk_mul_f32 v[66:67], v[66:67], s[62:63] op_sel_hi:[1,0]
    v_pk_mul_f32 v[68:69], v[68:69], s[62:63] op_sel_hi:[1,0]
    v_pk_mul_f32 v[70:71], v[70:71], s[62:63] op_sel_hi:[1,0]
    v_cvt_pk_bf16_f32 v96, v64, v65
    v_cvt_pk_bf16_f32 v97, v66, v67
    v_cvt_pk_bf16_f32 v98, v68, v69
    v_cvt_pk_bf16_f32 v99, v70, v71
    buffer_store_dwordx4 v[96:99], v1, s[48:51], s14 offen offset:0 sc1
    s_waitcnt lgkmcnt(2)
    v_pk_add_f32 v[72:73], v[32:33], v[72:73]
    v_pk_add_f32 v[74:75], v[34:35], v[74:75]
    v_pk_add_f32 v[76:77], v[36:37], v[76:77]
    v_pk_add_f32 v[78:79], v[38:39], v[78:79]
    v_pk_mul_f32 v[72:73], v[72:73], s[62:63] op_sel_hi:[1,0]
    v_pk_mul_f32 v[74:75], v[74:75], s[62:63] op_sel_hi:[1,0]
    v_pk_mul_f32 v[76:77], v[76:77], s[62:63] op_sel_hi:[1,0]
    v_pk_mul_f32 v[78:79], v[78:79], s[62:63] op_sel_hi:[1,0]
    v_cvt_pk_bf16_f32 v100, v72, v73
    v_cvt_pk_bf16_f32 v101, v74, v75
    v_cvt_pk_bf16_f32 v102, v76, v77
    v_cvt_pk_bf16_f32 v103, v78, v79
    buffer_store_dwordx4 v[100:103], v1, s[48:51], s14 offen offset:1024 sc1
    s_waitcnt lgkmcnt(0)
    v_pk_add_f32 v[80:81], v[48:49], v[80:81]
    v_pk_add_f32 v[82:83], v[50:51], v[82:83]
    v_pk_add_f32 v[84:85], v[52:53], v[84:85]
    v_pk_add_f32 v[86:87], v[54:55], v[86:87]
    v_pk_mul_f32 v[80:81], v[80:81], s[62:63] op_sel_hi:[1,0]
    v_pk_mul_f32 v[82:83], v[82:83], s[62:63] op_sel_hi:[1,0]
    v_pk_mul_f32 v[84:85], v[84:85], s[62:63] op_sel_hi:[1,0]
    v_pk_mul_f32 v[86:87], v[86:87], s[62:63] op_sel_hi:[1,0]
    v_cvt_pk_bf16_f32 v104, v80, v81
    v_cvt_pk_bf16_f32 v105, v82, v83
    v_cvt_pk_bf16_f32 v106, v84, v85
    v_cvt_pk_bf16_f32 v107, v86, v87
    buffer_store_dwordx4 v[104:107], v1, s[48:51], s14 offen offset:2048 sc1
    s_branch L_aend_12
L_akh1_11:
    s_nop 6
    ds_write_b128 v140, v[16:19] offset:0
    ds_write_b128 v140, v[20:23] offset:1024
    ds_write_b128 v140, v[32:35] offset:2048
    ds_write_b128 v140, v[36:39] offset:3072
    ds_write_b128 v140, v[48:51] offset:4096
    ds_write_b128 v140, v[52:55] offset:5120
    s_mov_b32 s62, 0x3d553b95
    s_waitcnt lgkmcnt(0)
    s_barrier
    ds_read_b128 v[64:67], v141 offset:0
    ds_read_b128 v[68:71], v141 offset:1024
    ds_read_b128 v[72:75], v141 offset:2048
    ds_read_b128 v[76:79], v141 offset:3072
    ds_read_b128 v[80:83], v141 offset:4096
    ds_read_b128 v[84:87], v141 offset:5120
    s_waitcnt lgkmcnt(4)
    v_pk_add_f32 v[64:65], v[24:25], v[64:65]
    v_pk_add_f32 v[66:67], v[26:27], v[66:67]
    v_pk_add_f32 v[68:69], v[28:29], v[68:69]
    v_pk_add_f32 v[70:71], v[30:31], v[70:71]
    v_pk_mul_f32 v[64:65], v[64:65], s[62:63] op_sel_hi:[1,0]
    v_pk_mul_f32 v[66:67], v[66:67], s[62:63] op_sel_hi:[1,0]
    v_pk_mul_f32 v[68:69], v[68:69], s[62:63] op_sel_hi:[1,0]
    v_pk_mul_f32 v[70:71], v[70:71], s[62:63] op_sel_hi:[1,0]
    v_cvt_pk_bf16_f32 v96, v64, v65
    v_cvt_pk_bf16_f32 v97, v66, v67
    v_cvt_pk_bf16_f32 v98, v68, v69
    v_cvt_pk_bf16_f32 v99, v70, v71
    buffer_store_dwordx4 v[96:99], v1, s[48:51], s14 offen offset:0 sc1
    s_waitcnt lgkmcnt(2)
    v_pk_add_f32 v[72:73], v[40:41], v[72:73]
    v_pk_add_f32 v[74:75], v[42:43], v[74:75]
    v_pk_add_f32 v[76:77], v[44:45], v[76:77]
    v_pk_add_f32 v[78:79], v[46:47], v[78:79]
    v_pk_mul_f32 v[72:73], v[72:73], s[62:63] op_sel_hi:[1,0]
    v_pk_mul_f32 v[74:75], v[74:75], s[62:63] op_sel_hi:[1,0]
    v_pk_mul_f32 v[76:77], v[76:77], s[62:63] op_sel_hi:[1,0]
    v_pk_mul_f32 v[78:79], v[78:79], s[62:63] op_sel_hi:[1,0]
    v_cvt_pk_bf16_f32 v100, v72, v73
    v_cvt_pk_bf16_f32 v101, v74, v75
    v_cvt_pk_bf16_f32 v102, v76, v77
    v_cvt_pk_bf16_f32 v103, v78, v79
    buffer_store_dwordx4 v[100:103], v1, s[48:51], s14 offen offset:1024 sc1
    s_waitcnt lgkmcnt(0)
    v_pk_add_f32 v[80:81], v[56:57], v[80:81]
    v_pk_add_f32 v[82:83], v[58:59], v[82:83]
    v_pk_add_f32 v[84:85], v[60:61], v[84:85]
    v_pk_add_f32 v[86:87], v[62:63], v[86:87]
    v_pk_mul_f32 v[80:81], v[80:81], s[62:63] op_sel_hi:[1,0]
    v_pk_mul_f32 v[82:83], v[82:83], s[62:63] op_sel_hi:[1,0]
    v_pk_mul_f32 v[84:85], v[84:85], s[62:63] op_sel_hi:[1,0]
    v_pk_mul_f32 v[86:87], v[86:87], s[62:63] op_sel_hi:[1,0]
    v_cvt_pk_bf16_f32 v104, v80, v81
    v_cvt_pk_bf16_f32 v105, v82, v83
    v_cvt_pk_bf16_f32 v106, v84, v85
    v_cvt_pk_bf16_f32 v107, v86, v87
    buffer_store_dwordx4 v[104:107], v1, s[48:51], s14 offen offset:2048 sc1
L_aend_12:
    s_barrier
    s_branch L_A_done
L_A_w:
    s_sub_u32 s32, s10, 4096
    s_subb_u32 s33, s11, 0
    s_mov_b32 s34, 1183744
    s_mov_b32 s35, 0x20000
    s_lshr_b32 s57, s52, 1
    s_and_b32 s57, s57, 1
    s_lshl_b32 s57, s57, 2
    s_and_b32 s58, s53, 3
    s_add_u32 s64, s58, s57
    s_lshr_b32 s57, s52, 0
    s_and_b32 s57, s57, 1
    s_xor_b32 s57, s57, 1
    s_mul_i32 s57, s57, 6
    s_lshr_b32 s62, s53, 2
    s_add_u32 s65, s62, s57
    s_mul_i32 s58, s58, 3
    s_lshl_b32 s62, s62, 1
    s_add_u32 s59, s58, s62
    s_cmp_ge_u32 s59, 12
    s_cselect_b32 s58, 12, 0
    s_sub_u32 s59, s59, s58
    s_and_b32 s94, s3, 1
    s_lshr_b32 s95, s3, 1
    v_lshrrev_b32 v9, 3, v0
    v_and_b32 v10, 7, v0
    v_lshrrev_b32 v11, 4, v0
    v_mul_u32_u24 v12, 4608, v9
    v_xor_b32 v13, v10, v11
    v_xor_b32 v14, 4, v13
    v_lshl_add_u32 v13, v13, 4, v12
    v_lshl_add_u32 v14, v14, 4, v12
    v_and_b32 v15, 1, v11
    v_lshlrev_b32 v15, 2, v15
    v_xor_b32 v15, v10, v15
    v_mul_u32_u24 v12, 1536, v9
    v_lshl_add_u32 v15, v15, 4, v12
    s_lshl_b32 s60, s65, 7
    s_mul_i32 s57, s3, 24576
    s_add_u32 s60, s60, s57
    s_add_u32 s60, s60, 4096
    v_add_u32 v4, s60, v15
    s_add_u32 s57, s60, 11264
    v_add_u32 v5, s57, v15
    s_mul_i32 s61, s64, 442368
    s_mul_i32 s57, s3, 110592
    s_add_u32 s61, s61, s57
    s_add_u32 s61, s61, 7168
    s_cmp_eq_u32 s94, 0
    s_cselect_b64 vcc, -1, 0
    v_cndmask_b32 v15, v14, v13, vcc
    v_cndmask_b32 v9, v13, v14, vcc
    v_add_u32 v6, s61, v15
    s_add_u32 s57, s61, 35840
    v_add_u32 v7, s57, v9
    s_add_u32 s57, s61, 71680
    v_add_u32 v8, s57, v15
    s_lshl_b32 s66, s3, 11
    s_mul_i32 s67, s3, 3072
    s_add_u32 s67, s67, 8192
    s_lshl_b32 s68, s59, 7
    s_mul_i32 s69, s59, 98304
    s_add_u32 m0, s66, 0
    s_nop 0
    buffer_load_dwordx4 v4, s[32:35], s69 offen lds
    buffer_load_dwordx4 v5, s[32:35], s69 offen offset:1024 lds
    s_add_u32 m0, s67, 0
    s_nop 0
    buffer_load_dwordx4 v6, s[28:31], s68 offen offset:0 lds
    buffer_load_dwordx4 v7, s[28:31], s68 offen offset:1024 lds
    buffer_load_dwordx4 v8, s[28:31], s68 offen offset:2048 lds
    s_add_u32 s59, s59, 1
    s_cmp_eq_u32 s59, 12
    s_cselect_b32 s59, 0, s59
    s_lshl_b32 s68, s59, 7
    s_mul_i32 s69, s59, 98304
    s_add_u32 m0, s66, 20480
    s_nop 0
    buffer_load_dwordx4 v4, s[32:35], s69 offen lds
    buffer_load_dwordx4 v5, s[32:35], s69 offen offset:1024 lds
    s_add_u32 m0, s67, 20480
    s_nop 0
    buffer_load_dwordx4 v6, s[28:31], s68 offen offset:0 lds
    buffer_load_dwordx4 v7, s[28:31], s68 offen offset:1024 lds
    buffer_load_dwordx4 v8, s[28:31], s68 offen offset:2048 lds
    s_add_u32 s59, s59, 1
    s_cmp_eq_u32 s59, 12
    s_cselect_b32 s59, 0, s59
    s_lshl_b32 s68, s59, 7
    s_mul_i32 s69, s59, 98304
    s_add_u32 m0, s66, 40960
    s_nop 0
    buffer_load_dwordx4 v4, s[32:35], s69 offen lds
    buffer_load_dwordx4 v5, s[32:35], s69 offen offset:1024 lds
    s_add_u32 m0, s67, 40960
    s_nop 0
    buffer_load_dwordx4 v6, s[28:31], s68 offen offset:0 lds
    buffer_load_dwordx4 v7, s[28:31], s68 offen offset:1024 lds
    buffer_load_dwordx4 v8, s[28:31], s68 offen offset:2048 lds
    s_add_u32 s59, s59, 1
    s_cmp_eq_u32 s59, 12
    s_cselect_b32 s59, 0, s59
    s_lshr_b32 s57, s52, 1
    s_lshl_b32 s57, s57, 2
    s_and_b32 s58, s53, 3
    s_add_u32 s54, s57, s58
    s_and_b32 s57, s52, 1
    s_lshl_b32 s57, s57, 3
    s_lshr_b32 s58, s53, 2
    s_add_u32 s55, s57, s58
    v_and_b32 v20, 31, v0
    v_lshrrev_b32 v21, 5, v0
    v_lshrrev_b32 v22, 1, v20
    v_and_b32 v22, 7, v22
    s_lshl_b32 s57, s95, 2
    v_add_u32 v23, s57, v21
    v_add_u32 v24, 0, v23
    v_xor_b32 v24, v24, v22
    v_lshlrev_b32 v24, 4, v24
    v_lshl_add_u32 v24, v20, 7, v24
    v_add_u32 v106, 8192, v24
    v_add_u32 v107, 69632, v24
    v_add_u32 v108, 131072, v24
    v_add_u32 v24, 2, v23
    v_xor_b32 v24, v24, v22
    v_lshlrev_b32 v24, 4, v24
    v_lshl_add_u32 v24, v20, 7, v24
    v_add_u32 v109, 8192, v24
    v_add_u32 v110, 69632, v24
    v_add_u32 v111, 131072, v24
    v_lshrrev_b32 v24, 2, v0
    v_and_b32 v24, 3, v24
    v_lshrrev_b32 v25, 1, v24
    s_lshl_b32 s57, s95, 5
    v_lshl_add_u32 v24, v21, 3, v24
    v_add_u32 v24, s57, v24
    v_lshlrev_b32 v24, 7, v24
    v_xor_b32 v25, s94, v25
    v_lshl_add_u32 v24, v25, 6, v24
    v_lshrrev_b32 v25, 4, v0
    v_and_b32 v25, 1, v25
    v_lshl_add_u32 v24, v25, 5, v24
    v_and_b32 v25, 3, v0
    v_lshl_add_u32 v100, v25, 3, v24
    v_add_u32 v101, 61440, v100
    v_add_u32 v102, 122880, v100
    s_waitcnt vmcnt(10)
    s_barrier
    ds_read_b64_tr_b16 a[0:1], v100 offset:0
    ds_read_b64_tr_b16 a[2:3], v100 offset:512
    ds_read_b128 a[8:11], v106 offset:0
    ds_read_b128 a[12:15], v106 offset:4096
    ds_read_b128 a[16:19], v106 offset:8192
    ds_read_b64_tr_b16 a[4:5], v100 offset:2048
    ds_read_b64_tr_b16 a[6:7], v100 offset:2560
    ds_read_b128 a[20:23], v109 offset:0
    ds_read_b128 a[24:27], v109 offset:4096
    ds_read_b128 a[28:31], v109 offset:8192
    s_waitcnt vmcnt(5)
    s_barrier
    s_waitcnt lgkmcnt(5)
    v_mfma_f32_32x32x16_bf16 v[16:31], a[8:11], a[0:3], 0
    ds_read_b64_tr_b16 a[32:33], v100 offset:20480
    ds_read_b64_tr_b16 a[34:35], v100 offset:20992
    ds_read_b128 a[40:43], v106 offset:20480
    ds_read_b128 a[44:47], v106 offset:24576
    s_lshl_b32 s68, s59, 7
    s_mul_i32 s69, s59, 98304
    s_add_u32 m0, s66, 61440
    s_nop 0
    buffer_load_dwordx4 v4, s[32:35], s69 offen lds
    buffer_load_dwordx4 v5, s[32:35], s69 offen offset:1024 lds
    v_mfma_f32_32x32x16_bf16 v[32:47], a[12:15], a[0:3], 0
    ds_read_b128 a[48:51], v106 offset:28672
    ds_read_b64_tr_b16 a[36:37], v100 offset:22528
    ds_read_b64_tr_b16 a[38:39], v100 offset:23040
    ds_read_b128 a[52:55], v109 offset:20480
    s_add_u32 m0, s67, 61440
    s_nop 0
    buffer_load_dwordx4 v6, s[28:31], s68 offen offset:0 lds
    buffer_load_dwordx4 v7, s[28:31], s68 offen offset:1024 lds
    v_mfma_f32_32x32x16_bf16 v[48:63], a[16:19], a[0:3], 0
    ds_read_b128 a[56:59], v109 offset:24576
    ds_read_b128 a[60:63], v109 offset:28672
    buffer_load_dwordx4 v8, s[28:31], s68 offen offset:2048 lds
    s_add_u32 s59, s59, 1
    s_cmp_eq_u32 s59, 12
    s_cselect_b32 s59, 0, s59
    s_lshl_b32 s68, s59, 7
    s_mul_i32 s69, s59, 98304
    s_add_u32 m0, s66, 81920
    s_nop 0
    buffer_load_dwordx4 v4, s[32:35], s69 offen lds
    s_waitcnt lgkmcnt(10)
    v_mfma_f32_32x32x16_bf16 v[16:31], a[20:23], a[4:7], v[16:31]
    buffer_load_dwordx4 v5, s[32:35], s69 offen offset:1024 lds
    s_add_u32 m0, s67, 81920
    s_nop 0
    buffer_load_dwordx4 v6, s[28:31], s68 offen offset:0 lds
    v_mfma_f32_32x32x16_bf16 v[32:47], a[24:27], a[4:7], v[32:47]
    buffer_load_dwordx4 v7, s[28:31], s68 offen offset:1024 lds
    buffer_load_dwordx4 v8, s[28:31], s68 offen offset:2048 lds
    s_add_u32 s59, s59, 1
    s_cmp_eq_u32 s59, 12
    s_cselect_b32 s59, 0, s59
    v_mfma_f32_32x32x16_bf16 v[48:63], a[28:31], a[4:7], v[48:63]
    s_waitcnt vmcnt(10)
    s_barrier
    s_waitcnt lgkmcnt(5)
    v_mfma_f32_32x32x16_bf16 v[16:31], a[40:43], a[32:35], v[16:31]
    ds_read_b64_tr_b16 a[0:1], v100 offset:40960
    ds_read_b64_tr_b16 a[2:3], v100 offset:41472
    ds_read_b128 a[8:11], v106 offset:40960
    ds_read_b128 a[12:15], v106 offset:45056
    s_lshl_b32 s68, s59, 7
    s_mul_i32 s69, s59, 98304
    s_add_u32 m0, s66, 102400
    s_nop 0
    buffer_load_dwordx4 v4, s[32:35], s69 offen lds
    v_mfma_f32_32x32x16_bf16 v[32:47], a[44:47], a[32:35], v[32:47]
    ds_read_b128 a[16:19], v106 offset:49152
    ds_read_b64_tr_b16 a[4:5], v100 offset:43008
    ds_read_b64_tr_b16 a[6:7], v100 offset:43520
    ds_read_b128 a[20:23], v109 offset:40960
    buffer_load_dwordx4 v5, s[32:35], s69 offen offset:1024 lds
    v_mfma_f32_32x32x16_bf16 v[48:63], a[48:51], a[32:35], v[48:63]
    ds_read_b128 a[24:27], v109 offset:45056
    ds_read_b128 a[28:31], v109 offset:49152
    s_add_u32 m0, s67, 102400
    s_nop 0
    buffer_load_dwordx4 v6, s[28:31], s68 offen offset:0 lds
    s_waitcnt lgkmcnt(10)
    v_mfma_f32_32x32x16_bf16 v[16:31], a[52:55], a[36:39], v[16:31]
    buffer_load_dwordx4 v7, s[28:31], s68 offen offset:1024 lds
    v_mfma_f32_32x32x16_bf16 v[32:47], a[56:59], a[36:39], v[32:47]
    buffer_load_dwordx4 v8, s[28:31], s68 offen offset:2048 lds
    s_add_u32 s59, s59, 1
    s_cmp_eq_u32 s59, 12
    s_cselect_b32 s59, 0, s59
    v_mfma_f32_32x32x16_bf16 v[48:63], a[60:63], a[36:39], v[48:63]
    s_waitcnt vmcnt(10)
    s_barrier
    s_waitcnt lgkmcnt(5)
    v_mfma_f32_32x32x16_bf16 v[16:31], a[8:11], a[0:3], v[16:31]
    ds_read_b64_tr_b16 a[32:33], v101 offset:0
    ds_read_b64_tr_b16 a[34:35], v101 offset:512
    ds_read_b128 a[40:43], v107 offset:0
    ds_read_b128 a[44:47], v107 offset:4096
    s_lshl_b32 s68, s59, 7
    s_mul_i32 s69, s59, 98304
    s_add_u32 m0, s66, 122880
    s_nop 0
    buffer_load_dwordx4 v4, s[32:35], s69 offen lds
    buffer_load_dwordx4 v5, s[32:35], s69 offen offset:1024 lds
    v_mfma_f32_32x32x16_bf16 v[32:47], a[12:15], a[0:3], v[32:47]
    ds_read_b128 a[48:51], v107 offset:8192
    ds_read_b64_tr_b16 a[36:37], v101 offset:2048
    ds_read_b64_tr_b16 a[38:39], v101 offset:2560
    ds_read_b128 a[52:55], v110 offset:0
    s_add_u32 m0, s67, 122880
    s_nop 0
    buffer_load_dwordx4 v6, s[28:31], s68 offen offset:0 lds
    buffer_load_dwordx4 v7, s[28:31], s68 offen offset:1024 lds
    v_mfma_f32_32x32x16_bf16 v[48:63], a[16:19], a[0:3], v[48:63]
    ds_read_b128 a[56:59], v110 offset:4096
    ds_read_b128 a[60:63], v110 offset:8192
    buffer_load_dwordx4 v8, s[28:31], s68 offen offset:2048 lds
    s_add_u32 s59, s59, 1
    s_cmp_eq_u32 s59, 12
    s_cselect_b32 s59, 0, s59
    s_lshl_b32 s68, s59, 7
    s_mul_i32 s69, s59, 98304
    s_add_u32 m0, s66, 143360
    s_nop 0
    buffer_load_dwordx4 v4, s[32:35], s69 offen lds
    s_waitcnt lgkmcnt(10)
    v_mfma_f32_32x32x16_bf16 v[16:31], a[20:23], a[4:7], v[16:31]
    buffer_load_dwordx4 v5, s[32:35], s69 offen offset:1024 lds
    s_add_u32 m0, s67, 143360
    s_nop 0
    buffer_load_dwordx4 v6, s[28:31], s68 offen offset:0 lds
    v_mfma_f32_32x32x16_bf16 v[32:47], a[24:27], a[4:7], v[32:47]
    buffer_load_dwordx4 v7, s[28:31], s68 offen offset:1024 lds
    buffer_load_dwordx4 v8, s[28:31], s68 offen offset:2048 lds
    s_add_u32 s59, s59, 1
    s_cmp_eq_u32 s59, 12
    s_cselect_b32 s59, 0, s59
    v_mfma_f32_32x32x16_bf16 v[48:63], a[28:31], a[4:7], v[48:63]
    s_waitcnt vmcnt(15)
    s_barrier
    s_waitcnt lgkmcnt(5)
    v_mfma_f32_32x32x16_bf16 v[16:31], a[40:43], a[32:35], v[16:31]
    ds_read_b64_tr_b16 a[0:1], v101 offset:20480
    ds_read_b64_tr_b16 a[2:3], v101 offset:20992
    ds_read_b128 a[8:11], v107 offset:20480
    ds_read_b128 a[12:15], v107 offset:24576
    s_lshl_b32 s68, s59, 7
    s_mul_i32 s69, s59, 98304
    s_add_u32 m0, s66, 0
    s_nop 0
    buffer_load_dwordx4 v4, s[32:35], s69 offen lds
    v_mfma_f32_32x32x16_bf16 v[32:47], a[44:47], a[32:35], v[32:47]
    ds_read_b128 a[16:19], v107 offset:28672
    ds_read_b64_tr_b16 a[4:5], v101 offset:22528
    ds_read_b64_tr_b16 a[6:7], v101 offset:23040
    ds_read_b128 a[20:23], v110 offset:20480
    buffer_load_dwordx4 v5, s[32:35], s69 offen offset:1024 lds
    v_mfma_f32_32x32x16_bf16 v[48:63], a[48:51], a[32:35], v[48:63]
    ds_read_b128 a[24:27], v110 offset:24576
    ds_read_b128 a[28:31], v110 offset:28672
    s_add_u32 m0, s67, 0
    s_nop 0
    buffer_load_dwordx4 v6, s[28:31], s68 offen offset:0 lds
    s_waitcnt lgkmcnt(10)
    v_mfma_f32_32x32x16_bf16 v[16:31], a[52:55], a[36:39], v[16:31]
    buffer_load_dwordx4 v7, s[28:31], s68 offen offset:1024 lds
    v_mfma_f32_32x32x16_bf16 v[32:47], a[56:59], a[36:39], v[32:47]
    buffer_load_dwordx4 v8, s[28:31], s68 offen offset:2048 lds
    s_add_u32 s59, s59, 1
    s_cmp_eq_u32 s59, 12
    s_cselect_b32 s59, 0, s59
    v_mfma_f32_32x32x16_bf16 v[48:63], a[60:63], a[36:39], v[48:63]
    s_waitcnt vmcnt(15)
    s_barrier
    s_waitcnt lgkmcnt(5)
    v_mfma_f32_32x32x16_bf16 v[16:31], a[8:11], a[0:3], v[16:31]
    ds_read_b64_tr_b16 a[32:33], v101 offset:40960
    ds_read_b64_tr_b16 a[34:35], v101 offset:41472
    ds_read_b128 a[40:43], v107 offset:40960
    ds_read_b128 a[44:47], v107 offset:45056
    s_lshl_b32 s68, s59, 7
    s_mul_i32 s69, s59, 98304
    s_add_u32 m0, s66, 20480
    s_nop 0
    buffer_load_dwordx4 v4, s[32:35], s69 offen lds
    v_mfma_f32_32x32x16_bf16 v[32:47], a[12:15], a[0:3], v[32:47]
    ds_read_b128 a[48:51], v107 offset:49152
    ds_read_b64_tr_b16 a[36:37], v101 offset:43008
    ds_read_b64_tr_b16 a[38:39], v101 offset:43520
    ds_read_b128 a[52:55], v110 offset:40960
    buffer_load_dwordx4 v5, s[32:35], s69 offen offset:1024 lds
    v_mfma_f32_32x32x16_bf16 v[48:63], a[16:19], a[0:3], v[48:63]
    ds_read_b128 a[56:59], v110 offset:45056
    ds_read_b128 a[60:63], v110 offset:49152
    s_add_u32 m0, s67, 20480
    s_nop 0
    buffer_load_dwordx4 v6, s[28:31], s68 offen offset:0 lds
    s_waitcnt lgkmcnt(10)
    v_mfma_f32_32x32x16_bf16 v[16:31], a[20:23], a[4:7], v[16:31]
    buffer_load_dwordx4 v7, s[28:31], s68 offen offset:1024 lds
    v_mfma_f32_32x32x16_bf16 v[32:47], a[24:27], a[4:7], v[32:47]
    buffer_load_dwordx4 v8, s[28:31], s68 offen offset:2048 lds
    s_add_u32 s59, s59, 1
    s_cmp_eq_u32 s59, 12
    s_cselect_b32 s59, 0, s59
    v_mfma_f32_32x32x16_bf16 v[48:63], a[28:31], a[4:7], v[48:63]
    s_waitcnt vmcnt(15)
    s_barrier
    s_waitcnt lgkmcnt(5)
    v_mfma_f32_32x32x16_bf16 v[16:31], a[40:43], a[32:35], v[16:31]
    ds_read_b64_tr_b16 a[0:1], v102 offset:0
    ds_read_b64_tr_b16 a[2:3], v102 offset:512
    ds_read_b128 a[8:11], v108 offset:0
    ds_read_b128 a[12:15], v108 offset:4096
    s_lshl_b32 s68, s59, 7
    s_mul_i32 s69, s59, 98304
    s_add_u32 m0, s66, 40960
    s_nop 0
    buffer_load_dwordx4 v4, s[32:35], s69 offen lds
    v_mfma_f32_32x32x16_bf16 v[32:47], a[44:47], a[32:35], v[32:47]
    ds_read_b128 a[16:19], v108 offset:8192
    ds_read_b64_tr_b16 a[4:5], v102 offset:2048
    ds_read_b64_tr_b16 a[6:7], v102 offset:2560
    ds_read_b128 a[20:23], v111 offset:0
    buffer_load_dwordx4 v5, s[32:35], s69 offen offset:1024 lds
    v_mfma_f32_32x32x16_bf16 v[48:63], a[48:51], a[32:35], v[48:63]
    ds_read_b128 a[24:27], v111 offset:4096
    ds_read_b128 a[28:31], v111 offset:8192
    s_add_u32 m0, s67, 40960
    s_nop 0
    buffer_load_dwordx4 v6, s[28:31], s68 offen offset:0 lds
    s_waitcnt lgkmcnt(10)
    v_mfma_f32_32x32x16_bf16 v[16:31], a[52:55], a[36:39], v[16:31]
    buffer_load_dwordx4 v7, s[28:31], s68 offen offset:1024 lds
    v_mfma_f32_32x32x16_bf16 v[32:47], a[56:59], a[36:39], v[32:47]
    buffer_load_dwordx4 v8, s[28:31], s68 offen offset:2048 lds
    s_add_u32 s59, s59, 1
    s_cmp_eq_u32 s59, 12
    s_cselect_b32 s59, 0, s59
    v_mfma_f32_32x32x16_bf16 v[48:63], a[60:63], a[36:39], v[48:63]
    buffer_load_dwordx2 v[2:3], off, s[44:47], 0 sc1
    s_waitcnt vmcnt(16)
    s_barrier
    s_waitcnt lgkmcnt(5)
    v_mfma_f32_32x32x16_bf16 v[16:31], a[8:11], a[0:3], v[16:31]
    ds_read_b64_tr_b16 a[32:33], v102 offset:20480
    ds_read_b64_tr_b16 a[34:35], v102 offset:20992
    ds_read_b128 a[40:43], v108 offset:20480
    ds_read_b128 a[44:47], v108 offset:24576
    s_lshl_b32 s68, s59, 7
    s_mul_i32 s69, s59, 98304
    s_add_u32 m0, s66, 61440
    s_nop 0
    buffer_load_dwordx4 v4, s[32:35], s69 offen lds
    v_mfma_f32_32x32x16_bf16 v[32:47], a[12:15], a[0:3], v[32:47]
    ds_read_b128 a[48:51], v108 offset:28672
    ds_read_b64_tr_b16 a[36:37], v102 offset:22528
    ds_read_b64_tr_b16 a[38:39], v102 offset:23040
    ds_read_b128 a[52:55], v111 offset:20480
    buffer_load_dwordx4 v5, s[32:35], s69 offen offset:1024 lds
    v_mfma_f32_32x32x16_bf16 v[48:63], a[16:19], a[0:3], v[48:63]
    ds_read_b128 a[56:59], v111 offset:24576
    ds_read_b128 a[60:63], v111 offset:28672
    s_add_u32 m0, s67, 61440
    s_nop 0
    buffer_load_dwordx4 v6, s[28:31], s68 offen offset:0 lds
    s_waitcnt lgkmcnt(10)
    v_mfma_f32_32x32x16_bf16 v[16:31], a[20:23], a[4:7], v[16:31]
    buffer_load_dwordx4 v7, s[28:31], s68 offen offset:1024 lds
    v_mfma_f32_32x32x16_bf16 v[32:47], a[24:27], a[4:7], v[32:47]
    buffer_load_dwordx4 v8, s[28:31], s68 offen offset:2048 lds
    s_add_u32 s59, s59, 1
    s_cmp_eq_u32 s59, 12
    s_cselect_b32 s59, 0, s59
    v_mfma_f32_32x32x16_bf16 v[48:63], a[28:31], a[4:7], v[48:63]
    s_waitcnt vmcnt(16)
    s_barrier
    s_waitcnt lgkmcnt(5)
    v_mfma_f32_32x32x16_bf16 v[16:31], a[40:43], a[32:35], v[16:31]
    ds_read_b64_tr_b16 a[0:1], v100 offset:0
    ds_read_b64_tr_b16 a[2:3], v100 offset:512
    ds_read_b128 a[8:11], v106 offset:0
    ds_read_b128 a[12:15], v106 offset:4096
    v_mfma_f32_32x32x16_bf16 v[32:47], a[44:47], a[32:35], v[32:47]
    ds_read_b128 a[16:19], v106 offset:8192
    ds_read_b64_tr_b16 a[4:5], v100 offset:2048
    ds_read_b64_tr_b16 a[6:7], v100 offset:2560
    ds_read_b128 a[20:23], v109 offset:0
    v_mfma_f32_32x32x16_bf16 v[48:63], a[48:51], a[32:35], v[48:63]
    ds_read_b128 a[24:27], v109 offset:4096
    ds_read_b128 a[28:31], v109 offset:8192
    s_waitcnt lgkmcnt(10)
    v_mfma_f32_32x32x16_bf16 v[16:31], a[52:55], a[36:39], v[16:31]
    v_mfma_f32_32x32x16_bf16 v[32:47], a[56:59], a[36:39], v[32:47]
    v_mfma_f32_32x32x16_bf16 v[48:63], a[60:63], a[36:39], v[48:63]
    s_mov_b32 s24, s6
    s_mov_b32 s25, s7
    s_mov_b32 s26, 3072
    s_mov_b32 s27, 0x20000
    s_mov_b32 s36, s12
    s_mov_b32 s37, s13
    s_mov_b32 s38, 7077888
    s_mov_b32 s39, 0x20000
    s_min_u32 s58, s53, 5
    s_mul_i32 s57, s52, 6
    s_add_u32 s57, s57, s58
    s_mul_i32 s9, s57, 43
    s_lshr_b32 s9, s9, 9
    s_mul_i32 s8, s9, 12
    s_sub_u32 s8, s57, s8
    s_mul_i32 s57, s9, 192
    s_mul_i32 s58, s3, 48
    s_add_u32 s57, s57, s58
    s_lshl_b32 s58, s57, 1
    v_lshl_add_u32 v12, v0, 2, s58
    v_lshrrev_b32 v13, 3, v0
    v_mul_u32_u24 v14, 9216, v13
    v_and_b32 v15, 7, v0
    v_lshl_add_u32 v14, v15, 4, v14
    s_mul_i32 s10, s57, 9216
    s_lshl_b32 s58, s8, 7
    s_add_u32 s10, s10, s58
    s_add_u32 s10, s10, 3072
    s_mul_i32 s11, s3, 6144
    s_add_u32 s11, s11, 81920
    s_cmp_lt_u32 s53, 6
    s_cselect_b32 s58, 0, 0x10000000
    s_add_u32 s10, s10, s58
    buffer_load_dword v112, v12, s[24:27], s58 offen offset:0
    buffer_load_dword v113, v12, s[24:27], s58 offen offset:1536
    s_add_u32 m0, s11, 0
    s_nop 0
    buffer_load_dwordx4 v14, s[36:39], s10 offen nt lds
    s_add_u32 s10, s10, 73728
    s_add_u32 m0, s11, 1024
    s_nop 0
    buffer_load_dwordx4 v14, s[36:39], s10 offen nt lds
    s_add_u32 s10, s10, 73728
    s_add_u32 m0, s11, 2048
    s_nop 0
    buffer_load_dwordx4 v14, s[36:39], s10 offen nt lds
    s_add_u32 s10, s10, 73728
    s_add_u32 m0, s11, 3072
    s_nop 0
    buffer_load_dwordx4 v14, s[36:39], s10 offen nt lds
    s_add_u32 s10, s10, 73728
    s_add_u32 m0, s11, 4096
    s_nop 0
    buffer_load_dwordx4 v14, s[36:39], s10 offen nt lds
    s_add_u32 s10, s10, 73728
    s_add_u32 m0, s11, 5120
    s_nop 0
    buffer_load_dwordx4 v14, s[36:39], s10 offen nt lds
    s_waitcnt vmcnt(19)
    s_barrier
    s_waitcnt lgkmcnt(5)
    v_mfma_f32_32x32x16_bf16 v[16:31], a[8:11], a[0:3], v[16:31]
    ds_read_b64_tr_b16 a[32:33], v100 offset:20480
    ds_read_b64_tr_b16 a[34:35], v100 offset:20992
    ds_read_b128 a[40:43], v106 offset:20480
    ds_read_b128 a[44:47], v106 offset:24576
    v_mfma_f32_32x32x16_bf16 v[32:47], a[12:15], a[0:3], v[32:47]
    ds_read_b128 a[48:51], v106 offset:28672
    ds_read_b64_tr_b16 a[36:37], v100 offset:22528
    ds_read_b64_tr_b16 a[38:39], v100 offset:23040
    ds_read_b128 a[52:55], v109 offset:20480
    v_mfma_f32_32x32x16_bf16 v[48:63], a[16:19], a[0:3], v[48:63]
    ds_read_b128 a[56:59], v109 offset:24576
    ds_read_b128 a[60:63], v109 offset:28672
    s_waitcnt lgkmcnt(10)
    v_mfma_f32_32x32x16_bf16 v[16:31], a[20:23], a[4:7], v[16:31]
    v_mfma_f32_32x32x16_bf16 v[32:47], a[24:27], a[4:7], v[32:47]
    v_mfma_f32_32x32x16_bf16 v[48:63], a[28:31], a[4:7], v[48:63]
    s_mul_i32 s57, s3, 6144
    v_add_u32 v140, s57, v1
    s_xor_b32 s57, s3, 2
    s_mul_i32 s57, s57, 6144
    v_add_u32 v141, s57, v1
    s_lshl_b32 s60, s65, 1
    s_add_u32 s60, s60, s94
    s_mul_i32 s58, s60, 43
    s_lshr_b32 s58, s58, 7
    s_mul_i32 s56, s58, 3
    s_sub_u32 s60, s60, s56
    s_add_u32 s58, s58, 8
    s_mul_i32 s56, s58, 48
    s_mul_i32 s57, s64, 6
    s_add_u32 s56, s56, s57
    s_add_u32 s56, s56, s95
    s_mul_i32 s14, s56, 3072
    s_lshl_b32 s56, s60, 10
    s_add_u32 s14, s14, s56
    s_lshl_b32 s60, s60, 4
    s_lshl_b32 s56, s64, 1
    s_add_u32 s60, s60, s56
    s_add_u32 s60, s60, s95
    s_lshl_b32 s57, s58, 6
    s_add_u32 s57, s57, s60
    s_lshl_b32 s57, s57, 3
    s_add_u32 s89, s57, 19542016
    s_mov_b32 s90, 0
    s_waitcnt vmcnt(14)
    s_barrier
    s_waitcnt lgkmcnt(5)
    v_mfma_f32_32x32x16_bf16 v[16:31], a[40:43], a[32:35], v[16:31]
    ds_read_b64_tr_b16 a[0:1], v100 offset:40960
    ds_read_b64_tr_b16 a[2:3], v100 offset:41472
    ds_read_b128 a[8:11], v106 offset:40960
    ds_read_b128 a[12:15], v106 offset:45056
    v_mfma_f32_32x32x16_bf16 v[32:47], a[44:47], a[32:35], v[32:47]
    ds_read_b128 a[16:19], v106 offset:49152
    ds_read_b64_tr_b16 a[4:5], v100 offset:43008
    ds_read_b64_tr_b16 a[6:7], v100 offset:43520
    ds_read_b128 a[20:23], v109 offset:40960
    v_mfma_f32_32x32x16_bf16 v[48:63], a[48:51], a[32:35], v[48:63]
    ds_read_b128 a[24:27], v109 offset:45056
    ds_read_b128 a[28:31], v109 offset:49152
    s_waitcnt lgkmcnt(10)
    v_mfma_f32_32x32x16_bf16 v[16:31], a[52:55], a[36:39], v[16:31]
    v_mfma_f32_32x32x16_bf16 v[32:47], a[56:59], a[36:39], v[32:47]
    v_mfma_f32_32x32x16_bf16 v[48:63], a[60:63], a[36:39], v[48:63]
    s_waitcnt vmcnt(8)
    s_barrier
    s_waitcnt lgkmcnt(5)
    v_mfma_f32_32x32x16_bf16 v[16:31], a[8:11], a[0:3], v[16:31]
    ds_read_b64_tr_b16 a[32:33], v101 offset:0
    ds_read_b64_tr_b16 a[34:35], v101 offset:512
    ds_read_b128 a[40:43], v107 offset:0
    ds_read_b128 a[44:47], v107 offset:4096
    v_mfma_f32_32x32x16_bf16 v[32:47], a[12:15], a[0:3], v[32:47]
    ds_read_b128 a[48:51], v107 offset:8192
    ds_read_b64_tr_b16 a[36:37], v101 offset:2048
    ds_read_b64_tr_b16 a[38:39], v101 offset:2560
    ds_read_b128 a[52:55], v110 offset:0
    v_mfma_f32_32x32x16_bf16 v[48:63], a[16:19], a[0:3], v[48:63]
    ds_read_b128 a[56:59], v110 offset:4096
    ds_read_b128 a[60:63], v110 offset:8192
    s_waitcnt lgkmcnt(10)
    v_mfma_f32_32x32x16_bf16 v[16:31], a[20:23], a[4:7], v[16:31]
    v_mfma_f32_32x32x16_bf16 v[32:47], a[24:27], a[4:7], v[32:47]
    v_mfma_f32_32x32x16_bf16 v[48:63], a[28:31], a[4:7], v[48:63]
    v_cmp_eq_u32 vcc, 0, v2
    s_cbranch_vccz L_nok_13
    s_mov_b32 s88, 0
L_nsp_14:
    buffer_load_dwordx2 v[2:3], off, s[44:47], 0 sc1
    s_waitcnt vmcnt(0)
    v_cmp_eq_u32 vcc, 0, v2
    s_cbranch_vccz L_nok_13
    s_add_u32 s88, s88, 1
    s_cmp_lt_u32 s88, 262144
    s_cbranch_scc1 L_nsp_14
L_nok_13:
    s_waitcnt lgkmcnt(5)
    v_mfma_f32_32x32x16_bf16 v[16:31], a[40:43], a[32:35], v[16:31]
    v_mfma_f32_32x32x16_bf16 v[32:47], a[44:47], a[32:35], v[32:47]
    v_mfma_f32_32x32x16_bf16 v[48:63], a[48:51], a[32:35], v[48:63]
    s_waitcnt lgkmcnt(0)
    v_mfma_f32_32x32x16_bf16 v[16:31], a[52:55], a[36:39], v[16:31]
    v_mfma_f32_32x32x16_bf16 v[32:47], a[56:59], a[36:39], v[32:47]
    v_mfma_f32_32x32x16_bf16 v[48:63], a[60:63], a[36:39], v[48:63]
    s_lshr_b32 s57, s3, 1
    s_cmp_eq_u32 s57, 0
    s_cbranch_scc0 L_akh1_15
    s_nop 6
    ds_write_b128 v140, v[24:27] offset:0
    ds_write_b128 v140, v[28:31] offset:1024
    ds_write_b128 v140, v[40:43] offset:2048
    ds_write_b128 v140, v[44:47] offset:3072
    ds_write_b128 v140, v[56:59] offset:4096
    ds_write_b128 v140, v[60:63] offset:5120
    s_waitcnt lgkmcnt(0)
    s_barrier
    ds_read_b128 v[64:67], v141 offset:0
    ds_read_b128 v[68:71], v141 offset:1024
    ds_read_b128 v[72:75], v141 offset:2048
    ds_read_b128 v[76:79], v141 offset:3072
    ds_read_b128 v[80:83], v141 offset:4096
    ds_read_b128 v[84:87], v141 offset:5120
    s_waitcnt lgkmcnt(4)
    v_pk_add_f32 v[64:65], v[16:17], v[64:65]
    v_pk_add_f32 v[66:67], v[18:19], v[66:67]
    v_pk_add_f32 v[68:69], v[20:21], v[68:69]
    v_pk_add_f32 v[70:71], v[22:23], v[70:71]
    v_cvt_pk_bf16_f32 v96, v64, v65
    v_cvt_pk_bf16_f32 v97, v66, v67
    v_cvt_pk_bf16_f32 v98, v68, v69
    v_cvt_pk_bf16_f32 v99, v70, v71
    buffer_store_dwordx4 v[96:99], v1, s[48:51], s14 offen sc1
    s_add_u32 s14, s14, 6144
    s_waitcnt lgkmcnt(2)
    v_pk_add_f32 v[72:73], v[32:33], v[72:73]
    v_pk_add_f32 v[74:75], v[34:35], v[74:75]
    v_pk_add_f32 v[76:77], v[36:37], v[76:77]
    v_pk_add_f32 v[78:79], v[38:39], v[78:79]
    v_cvt_pk_bf16_f32 v100, v72, v73
    v_cvt_pk_bf16_f32 v101, v74, v75
    v_cvt_pk_bf16_f32 v102, v76, v77
    v_cvt_pk_bf16_f32 v103, v78, v79
    buffer_store_dwordx4 v[100:103], v1, s[48:51], s14 offen sc1
    s_add_u32 s14, s14, 6144
    s_waitcnt lgkmcnt(0)
    v_pk_add_f32 v[80:81], v[48:49], v[80:81]
    v_pk_add_f32 v[82:83], v[50:51], v[82:83]
    v_pk_add_f32 v[84:85], v[52:53], v[84:85]
    v_pk_add_f32 v[86:87], v[54:55], v[86:87]
    v_cvt_pk_bf16_f32 v104, v80, v81
    v_cvt_pk_bf16_f32 v105, v82, v83
    v_cvt_pk_bf16_f32 v106, v84, v85
    v_cvt_pk_bf16_f32 v107, v86, v87
    buffer_store_dwordx4 v[104:107], v1, s[48:51], s14 offen sc1
    s_branch L_aend_16
L_akh1_15:
    s_nop 6
    ds_write_b128 v140, v[16:19] offset:0
    ds_write_b128 v140, v[20:23] offset:1024
    ds_write_b128 v140, v[32:35] offset:2048
    ds_write_b128 v140, v[36:39] offset:3072
    ds_write_b128 v140, v[48:51] offset:4096
    ds_write_b128 v140, v[52:55] offset:5120
    s_waitcnt lgkmcnt(0)
    s_barrier
    ds_read_b128 v[64:67], v141 offset:0
    ds_read_b128 v[68:71], v141 offset:1024
    ds_read_b128 v[72:75], v141 offset:2048
    ds_read_b128 v[76:79], v141 offset:3072
    ds_read_b128 v[80:83], v141 offset:4096
    ds_read_b128 v[84:87], v141 offset:5120
    s_waitcnt lgkmcnt(4)
    v_pk_add_f32 v[64:65], v[24:25], v[64:65]
    v_pk_add_f32 v[66:67], v[26:27], v[66:67]
    v_pk_add_f32 v[68:69], v[28:29], v[68:69]
    v_pk_add_f32 v[70:71], v[30:31], v[70:71]
    v_cvt_pk_bf16_f32 v96, v64, v65
    v_cvt_pk_bf16_f32 v97, v66, v67
    v_cvt_pk_bf16_f32 v98, v68, v69
    v_cvt_pk_bf16_f32 v99, v70, v71
    buffer_store_dwordx4 v[96:99], v1, s[48:51], s14 offen sc1
    s_add_u32 s14, s14, 6144
    s_waitcnt lgkmcnt(2)
    v_pk_add_f32 v[72:73], v[40:41], v[72:73]
    v_pk_add_f32 v[74:75], v[42:43], v[74:75]
    v_pk_add_f32 v[76:77], v[44:45], v[76:77]
    v_pk_add_f32 v[78:79], v[46:47], v[78:79]
    v_cvt_pk_bf16_f32 v100, v72, v73
    v_cvt_pk_bf16_f32 v101, v74, v75
    v_cvt_pk_bf16_f32 v102, v76, v77
    v_cvt_pk_bf16_f32 v103, v78, v79
    buffer_store_dwordx4 v[100:103], v1, s[48:51], s14 offen sc1
    s_add_u32 s14, s14, 6144
    s_waitcnt lgkmcnt(0)
    v_pk_add_f32 v[80:81], v[56:57], v[80:81]
    v_pk_add_f32 v[82:83], v[58:59], v[82:83]
    v_pk_add_f32 v[84:85], v[60:61], v[84:85]
    v_pk_add_f32 v[86:87], v[62:63], v[86:87]
    v_cvt_pk_bf16_f32 v104, v80, v81
    v_cvt_pk_bf16_f32 v105, v82, v83
    v_cvt_pk_bf16_f32 v106, v84, v85
    v_cvt_pk_bf16_f32 v107, v86, v87
    buffer_store_dwordx4 v[104:107], v1, s[48:51], s14 offen sc1
L_aend_16:
    s_barrier
L_A_done:
    s_lshl_b32 s57, s54, 2
    s_add_u32 s57, s57, s3
    s_mul_i32 s64, s57, 49152
    s_add_u32 s64, s64, 5242880
    s_lshl_b32 s57, s54, 9
    s_add_u32 s57, s57, 19529728
    s_lshr_b32 s59, s55, 1
    s_lshl_b32 s58, s59, 9
    s_add_u32 s58, s58, 19542016
    v_lshl_add_u32 v9, v0, 3, s58
    v_lshrrev_b32 v10, 2, v0
    v_and_b32 v10, 3, v10
    v_lshlrev_b32 v10, 7, v10
    v_and_b32 v11, 3, v0
    v_lshl_add_u32 v10, v11, 3, v10
    v_add_u32 v10, s57, v10
    v_cmp_le_u32 vcc, 48, v0
    v_add_u32 v11, 4096, v9
    s_nop 0
    v_cndmask_b32 v9, v9, v10, vcc
    v_mov_b32 v10, v11
    s_bfm_b64 s[56:57], 16, 0
    s_bfm_b64 s[12:13], 32, 16
    s_bitcmp1_b32 s55, 0
    s_cselect_b64 s[12:13], s[12:13], s[56:57]
    s_mul_i32 s56, s59, 147456
    s_mul_i32 s66, s3, 3072
    s_add_u32 s56, s56, s66
    s_add_u32 s57, s56, 1179648
    s_add_u32 s58, s56, 2048
    s_sub_u32 s59, s57, 2048
    s_bitcmp1_b32 s55, 0
    s_cselect_b32 s65, s58, s56
    s_cselect_b32 s68, s57, s56
    s_cselect_b32 s69, s57, s59
    s_mov_b32 s92, 0
    s_cmp_eq_u32 s3, 0
    s_cbranch_scc0 L_eo_17
    buffer_load_dwordx2 v[60:61], v9, s[48:51], 0 offen sc1
    s_waitcnt vmcnt(1)
    s_branch L_ej_18
L_eo_17:
    s_waitcnt vmcnt(0)
L_ej_18:
    s_cmp_eq_u32 s89, 0
    s_cbranch_scc1 L_np_19
    s_mov_b64 exec, 1
    buffer_store_dwordx2 v[2:3], off, s[48:51], s89 sc1
    s_mov_b64 exec, -1
L_np_19:
    s_cmp_ge_u32 s53, 6
    s_cbranch_scc1 L_gpr_20
    v_lshlrev_b32 v16, 16, v112
    v_and_b32 v17, s91, v112
    v_lshlrev_b32 v18, 16, v113
    v_and_b32 v19, s91, v113
    s_mov_b32 s57, 0xbfb8aa3b
    v_mul_f32 v32, s57, v16
    v_mul_f32 v33, s57, v17
    v_mul_f32 v34, s57, v18
    v_mul_f32 v35, s57, v19
    v_exp_f32 v32, v32
    v_exp_f32 v33, v33
    v_exp_f32 v34, v34
    v_exp_f32 v35, v35
    v_add_f32 v32, 1.0, v32
    v_add_f32 v33, 1.0, v33
    v_add_f32 v34, 1.0, v34
    v_add_f32 v35, 1.0, v35
    v_rcp_f32 v32, v32
    v_rcp_f32 v33, v33
    v_rcp_f32 v34, v34
    v_rcp_f32 v35, v35
    v_mul_f32 v16, v16, v32
    v_mul_f32 v17, v17, v33
    v_mul_f32 v18, v18, v34
    v_mul_f32 v19, v19, v35
    v_cvt_pk_bf16_f32 v40, v16, v17
    v_cvt_pk_bf16_f32 v41, v18, v19
    v_lshlrev_b32 v32, 16, v40
    v_and_b32 v33, s91, v40
    v_lshlrev_b32 v34, 16, v41
    v_and_b32 v35, s91, v41
    v_sub_f32 v16, v16, v32
    v_sub_f32 v17, v17, v33
    v_sub_f32 v18, v18, v34
    v_sub_f32 v19, v19, v35
    v_cvt_pk_bf16_f32 v44, v16, v17
    v_cvt_pk_bf16_f32 v45, v18, v19
    s_lshl_b32 s57, s3, 11
    s_add_u32 s57, s57, 147456
    v_lshl_add_u32 v12, v0, 2, s57
    s_bfm_b64 exec, 24, 0
    ds_write_b32 v12, v40 offset:0
    ds_write_b32 v12, v44 offset:192
    ds_write_b32 v12, v41 offset:96
    ds_write_b32 v12, v45 offset:288
    s_mov_b64 exec, -1
    v_and_b32 v12, 3, v0
    v_mul_u32_u24 v12, 96, v12
    v_lshrrev_b32 v16, 5, v0
    v_lshl_add_u32 v12, v16, 4, v12
    v_add_u32 v12, s57, v12
    v_lshrrev_b32 v13, 2, v0
    v_and_b32 v13, 3, v13
    v_lshl_add_u32 v13, v16, 3, v13
    v_lshlrev_b32 v13, 7, v13
    v_lshrrev_b32 v16, 4, v0
    v_and_b32 v16, 1, v16
    v_lshl_add_u32 v13, v16, 5, v13
    v_and_b32 v16, 3, v0
    v_lshl_add_u32 v13, v16, 3, v13
    s_mul_i32 s57, s3, 6144
    s_add_u32 s57, s57, 81920
    v_add_u32 v13, s57, v13
L_gpr_20:
    s_cmp_ge_u32 s53, 6
    s_cbranch_scc1 L_gun_21
    s_waitcnt lgkmcnt(0)
    ds_read_b128 a[0:3], v12 offset:0
    ds_read_b128 a[4:7], v12 offset:32
    ds_read_b128 a[8:11], v12 offset:64
    ds_read_b64_tr_b16 a[48:49], v13 offset:0
    ds_read_b64_tr_b16 a[50:51], v13 offset:512
    ds_read_b64_tr_b16 a[52:53], v13 offset:64
    ds_read_b64_tr_b16 a[54:55], v13 offset:576
    ds_read_b64_tr_b16 a[56:57], v13 offset:2048
    ds_read_b64_tr_b16 a[58:59], v13 offset:2560
    ds_read_b64_tr_b16 a[60:61], v13 offset:2112
    ds_read_b64_tr_b16 a[62:63], v13 offset:2624
    ds_read_b64_tr_b16 a[64:65], v13 offset:4096
    ds_read_b64_tr_b16 a[66:67], v13 offset:4608
    ds_read_b64_tr_b16 a[68:69], v13 offset:4160
    ds_read_b64_tr_b16 a[70:71], v13 offset:4672
    s_waitcnt lgkmcnt(8)
    v_mfma_f32_32x32x16_bf16 v[16:31], a[0:3], a[48:51], 0
    v_mfma_f32_32x32x16_bf16 v[32:47], a[0:3], a[52:55], 0
    s_waitcnt lgkmcnt(4)
    v_mfma_f32_32x32x16_bf16 v[16:31], a[4:7], a[56:59], v[16:31]
    v_mfma_f32_32x32x16_bf16 v[32:47], a[4:7], a[60:63], v[32:47]
    s_waitcnt lgkmcnt(0)
    v_mfma_f32_32x32x16_bf16 v[16:31], a[8:11], a[64:67], v[16:31]
    v_mfma_f32_32x32x16_bf16 v[32:47], a[8:11], a[68:71], v[32:47]
    s_lshl_b32 s57, s3, 9
    s_add_u32 s57, s57, 161792
    v_lshl_add_u32 v12, v0, 2, s57
    s_nop 7
    v_add_f32 v16, v16, v18
    v_add_f32 v17, v17, v19
    v_add_f32 v32, v32, v34
    v_add_f32 v33, v33, v35
    s_mov_b32 exec_hi, 0
    ds_write_b32 v12, v16 offset:0
    ds_write_b32 v12, v17 offset:256
    ds_write_b32 v12, v32 offset:128
    ds_write_b32 v12, v33 offset:384
    s_mov_b32 exec_hi, -1
    s_waitcnt lgkmcnt(0)
    s_barrier
    s_cmp_eq_u32 s3, 0
    s_cbranch_scc0 L_red_22
    v_lshlrev_b32 v12, 3, v0
    v_add_u32 v12, 161792, v12
    ds_read_b64 v[16:17], v12 offset:0
    ds_read_b64 v[18:19], v12 offset:512
    ds_read_b64 v[20:21], v12 offset:1024
    ds_read_b64 v[22:23], v12 offset:1536
    v_lshrrev_b32 v13, 5, v0
    v_and_b32 v14, 31, v0
    v_mul_u32_u24 v13, 3072, v13
    v_lshl_add_u32 v13, v14, 3, v13
    s_lshl_b32 s57, s8, 8
    s_mul_i32 s58, s9, 6144
    s_add_u32 s57, s57, s58
    s_add_u32 s57, s57, 19398656
    s_waitcnt lgkmcnt(0)
    v_pk_add_f32 v[16:17], v[16:17], v[18:19]
    v_pk_add_f32 v[20:21], v[20:21], v[22:23]
    v_pk_add_f32 v[16:17], v[16:17], v[20:21]
    buffer_store_dwordx2 v[16:17], v13, s[48:51], s57 offen sc1
L_red_22:
    s_lshl_b32 s57, s8, 2
    s_add_u32 s57, s57, s9
    s_lshl_b32 s57, s57, 3
    s_add_u32 s57, s57, 19537920
    s_cmp_eq_u32 s3, 0
    s_cselect_b32 s90, s57, 0
L_gun_21:
    s_cmp_eq_u32 s3, 0
    s_cbranch_scc0 L_wsp_23
    s_mov_b32 s88, 0
    s_waitcnt vmcnt(0)
    s_branch L_spc_26
L_spin_24:
    buffer_load_dwordx2 v[60:61], v9, s[48:51], 0 offen sc1
    s_waitcnt vmcnt(0)
L_spc_26:
    v_cmp_ne_u64 vcc, v[60:61], v[2:3]
    s_bfm_b64 s[56:57], 48, 0
    s_nop 1
    s_andn2_b64 s[14:15], vcc, s[56:57]
    s_and_b64 s[56:57], vcc, s[56:57]
    s_cbranch_scc0 L_spun_25
    s_add_u32 s88, s88, 1
    s_cmp_lt_u32 s88, 262144
    s_cbranch_scc1 L_spin_24
L_spun_25:
L_wsp_23:
    s_barrier
    s_bitcmp1_b32 s55, 0
    s_cbranch_scc1 L_wy_27
    s_add_u32 s67, s65, 0
    s_add_u32 m0, s66, 0
    s_nop 0
    buffer_load_dwordx4 v1, s[48:51], s67 offen offset:0 sc1 lds
    s_add_u32 s67, s68, 0
    buffer_load_dwordx4 v1, s[48:51], s67 offen offset:1024 sc1 lds
    s_add_u32 s67, s65, 12288
    s_add_u32 m0, s66, 12288
    s_nop 0
    buffer_load_dwordx4 v1, s[48:51], s67 offen offset:0 sc1 lds
    s_add_u32 s67, s68, 12288
    buffer_load_dwordx4 v1, s[48:51], s67 offen offset:1024 sc1 lds
    s_add_u32 s67, s65, 24576
    s_add_u32 m0, s66, 24576
    s_nop 0
    buffer_load_dwordx4 v1, s[48:51], s67 offen offset:0 sc1 lds
    s_add_u32 s67, s68, 24576
    buffer_load_dwordx4 v1, s[48:51], s67 offen offset:1024 sc1 lds
    s_add_u32 s67, s65, 36864
    s_add_u32 m0, s66, 36864
    s_nop 0
    buffer_load_dwordx4 v1, s[48:51], s67 offen offset:0 sc1 lds
    s_add_u32 s67, s68, 36864
    buffer_load_dwordx4 v1, s[48:51], s67 offen offset:1024 sc1 lds
    s_add_u32 s67, s65, 49152
    s_add_u32 m0, s66, 49152
    s_nop 0
    buffer_load_dwordx4 v1, s[48:51], s67 offen offset:0 sc1 lds
    s_add_u32 s67, s68, 49152
    buffer_load_dwordx4 v1, s[48:51], s67 offen offset:1024 sc1 lds
    s_add_u32 s67, s65, 61440
    s_add_u32 m0, s66, 61440
    s_nop 0
    buffer_load_dwordx4 v1, s[48:51], s67 offen offset:0 sc1 lds
    s_add_u32 s67, s68, 61440
    buffer_load_dwordx4 v1, s[48:51], s67 offen offset:1024 sc1 lds
    s_cmp_eq_u32 s3, 0
    s_cbranch_scc0 L_xp_29
    s_bfm_b64 exec, 16, 48
    buffer_load_dwordx2 v[12:13], v9, s[48:51], 0 offen sc1
    s_mov_b64 exec, -1
L_xp_29:
    s_add_u32 s67, s65, 73728
    s_add_u32 m0, s66, 73728
    s_nop 0
    buffer_load_dwordx4 v1, s[48:51], s67 offen offset:0 sc1 lds
    s_add_u32 s67, s68, 73728
    buffer_load_dwordx4 v1, s[48:51], s67 offen offset:1024 sc1 lds
    s_add_u32 s67, s65, 86016
    s_add_u32 m0, s66, 86016
    s_nop 0
    buffer_load_dwordx4 v1, s[48:51], s67 offen offset:0 sc1 lds
    s_add_u32 s67, s68, 86016
    buffer_load_dwordx4 v1, s[48:51], s67 offen offset:1024 sc1 lds
    s_add_u32 s67, s65, 98304
    s_add_u32 m0, s66, 98304
    s_nop 0
    buffer_load_dwordx4 v1, s[48:51], s67 offen offset:0 sc1 lds
    s_add_u32 s67, s68, 98304
    buffer_load_dwordx4 v1, s[48:51], s67 offen offset:1024 sc1 lds
    s_add_u32 s67, s65, 110592
    s_add_u32 m0, s66, 110592
    s_nop 0
    buffer_load_dwordx4 v1, s[48:51], s67 offen offset:0 sc1 lds
    s_add_u32 s67, s68, 110592
    buffer_load_dwordx4 v1, s[48:51], s67 offen offset:1024 sc1 lds
    s_add_u32 s67, s65, 122880
    s_add_u32 m0, s66, 122880
    s_nop 0
    buffer_load_dwordx4 v1, s[48:51], s67 offen offset:0 sc1 lds
    s_add_u32 s67, s68, 122880
    buffer_load_dwordx4 v1, s[48:51], s67 offen offset:1024 sc1 lds
    s_add_u32 s67, s65, 135168
    s_add_u32 m0, s66, 135168
    s_nop 0
    buffer_load_dwordx4 v1, s[48:51], s67 offen offset:0 sc1 lds
    s_add_u32 s67, s68, 135168
    buffer_load_dwordx4 v1, s[48:51], s67 offen offset:1024 sc1 lds
    s_branch L_wj_28
L_wy_27:
    s_add_u32 s67, s65, 0
    s_add_u32 m0, s66, 0
    s_nop 0
    buffer_load_dwordx4 v1, s[48:51], s67 offen offset:0 sc1 lds
    s_add_u32 s67, s65, 12288
    s_add_u32 m0, s66, 12288
    s_nop 0
    buffer_load_dwordx4 v1, s[48:51], s67 offen offset:0 sc1 lds
    s_add_u32 s67, s65, 24576
    s_add_u32 m0, s66, 24576
    s_nop 0
    buffer_load_dwordx4 v1, s[48:51], s67 offen offset:0 sc1 lds
    s_add_u32 s67, s65, 36864
    s_add_u32 m0, s66, 36864
    s_nop 0
    buffer_load_dwordx4 v1, s[48:51], s67 offen offset:0 sc1 lds
    s_cmp_eq_u32 s3, 0
    s_cbranch_scc0 L_yp_30
    s_bfm_b64 exec, 16, 48
    buffer_load_dwordx2 v[60:61], v9, s[48:51], 0 offen sc1
    s_mov_b64 exec, s[12:13]
    buffer_load_dwordx2 v[62:63], v10, s[48:51], 0 offen sc1
    s_mov_b64 exec, -1
L_yp_30:
    s_add_u32 s67, s65, 49152
    s_add_u32 m0, s66, 49152
    s_nop 0
    buffer_load_dwordx4 v1, s[48:51], s67 offen offset:0 sc1 lds
    s_add_u32 s67, s65, 61440
    s_add_u32 m0, s66, 61440
    s_nop 0
    buffer_load_dwordx4 v1, s[48:51], s67 offen offset:0 sc1 lds
    s_add_u32 s67, s65, 73728
    s_add_u32 m0, s66, 73728
    s_nop 0
    buffer_load_dwordx4 v1, s[48:51], s67 offen offset:0 sc1 lds
    s_add_u32 s67, s65, 86016
    s_add_u32 m0, s66, 86016
    s_nop 0
    buffer_load_dwordx4 v1, s[48:51], s67 offen offset:0 sc1 lds
    s_add_u32 s67, s65, 98304
    s_add_u32 m0, s66, 98304
    s_nop 0
    buffer_load_dwordx4 v1, s[48:51], s67 offen offset:0 sc1 lds
    s_add_u32 s67, s65, 110592
    s_add_u32 m0, s66, 110592
    s_nop 0
    buffer_load_dwordx4 v1, s[48:51], s67 offen offset:0 sc1 lds
    s_add_u32 s67, s65, 122880
    s_add_u32 m0, s66, 122880
    s_nop 0
    buffer_load_dwordx4 v1, s[48:51], s67 offen offset:0 sc1 lds
    s_add_u32 s67, s65, 135168
    s_add_u32 m0, s66, 135168
    s_nop 0
    buffer_load_dwordx4 v1, s[48:51], s67 offen offset:0 sc1 lds
    s_cmp_eq_u32 s3, 0
    s_cbranch_scc0 L_ysp_31
    s_waitcnt vmcnt(8)
    s_bfm_b64 exec, 16, 48
    v_cmp_ne_u64 vcc, v[60:61], v[2:3]
    s_nop 2
    s_mov_b64 s[14:15], vcc
    s_mov_b64 exec, s[12:13]
    v_cmp_ne_u64 vcc, v[62:63], v[2:3]
    s_mov_b64 exec, -1
    s_cbranch_vccz L_ysp_31
    s_mov_b32 s88, 0
L_spin_32:
    s_bfm_b64 exec, 16, 48
    buffer_load_dwordx2 v[60:61], v9, s[48:51], 0 offen sc1
    s_mov_b64 exec, s[12:13]
    buffer_load_dwordx2 v[62:63], v10, s[48:51], 0 offen sc1
    s_waitcnt vmcnt(0)
    s_bfm_b64 exec, 16, 48
    v_cmp_ne_u64 vcc, v[60:61], v[2:3]
    s_nop 2
    s_mov_b64 s[14:15], vcc
    s_mov_b64 exec, s[12:13]
    v_cmp_ne_u64 vcc, v[62:63], v[2:3]
    s_cbranch_vccz L_spun_33
    s_add_u32 s88, s88, 1
    s_cmp_lt_u32 s88, 262144
    s_cbranch_scc1 L_spin_32
L_spun_33:
    s_mov_b64 exec, -1
L_ysp_31:
    s_barrier
    s_cmp_eq_u32 s3, 0
    s_cbranch_scc0 L_xp_34
    s_bfm_b64 exec, 16, 48
    buffer_load_dwordx2 v[12:13], v9, s[48:51], 0 offen sc1
    s_mov_b64 exec, -1
L_xp_34:
    s_add_u32 s67, s68, 0
    s_add_u32 m0, s66, 0
    s_nop 0
    buffer_load_dwordx4 v1, s[48:51], s67 offen offset:1024 sc1 lds
    s_add_u32 s67, s68, 12288
    s_add_u32 m0, s66, 12288
    s_nop 0
    buffer_load_dwordx4 v1, s[48:51], s67 offen offset:1024 sc1 lds
    s_add_u32 s67, s68, 24576
    s_add_u32 m0, s66, 24576
    s_nop 0
    buffer_load_dwordx4 v1, s[48:51], s67 offen offset:1024 sc1 lds
    s_add_u32 s67, s68, 36864
    s_add_u32 m0, s66, 36864
    s_nop 0
    buffer_load_dwordx4 v1, s[48:51], s67 offen offset:1024 sc1 lds
    s_add_u32 s67, s68, 49152
    s_add_u32 m0, s66, 49152
    s_nop 0
    buffer_load_dwordx4 v1, s[48:51], s67 offen offset:1024 sc1 lds
    s_add_u32 s67, s68, 61440
    s_add_u32 m0, s66, 61440
    s_nop 0
    buffer_load_dwordx4 v1, s[48:51], s67 offen offset:1024 sc1 lds
    s_add_u32 s67, s68, 73728
    s_add_u32 m0, s66, 73728
    s_nop 0
    buffer_load_dwordx4 v1, s[48:51], s67 offen offset:1024 sc1 lds
    s_add_u32 s67, s68, 86016
    s_add_u32 m0, s66, 86016
    s_nop 0
    buffer_load_dwordx4 v1, s[48:51], s67 offen offset:1024 sc1 lds
    s_add_u32 s67, s68, 98304
    s_add_u32 m0, s66, 98304
    s_nop 0
    buffer_load_dwordx4 v1, s[48:51], s67 offen offset:1024 sc1 lds
    s_add_u32 s67, s68, 110592
    s_add_u32 m0, s66, 110592
    s_nop 0
    buffer_load_dwordx4 v1, s[48:51], s67 offen offset:1024 sc1 lds
    s_add_u32 s67, s68, 122880
    s_add_u32 m0, s66, 122880
    s_nop 0
    buffer_load_dwordx4 v1, s[48:51], s67 offen offset:1024 sc1 lds
    s_add_u32 s67, s68, 135168
    s_add_u32 m0, s66, 135168
    s_nop 0
    buffer_load_dwordx4 v1, s[48:51], s67 offen offset:1024 sc1 lds
L_wj_28:
    s_cmp_eq_u32 s3, 0
    s_cbranch_scc0 L_xsp_35
    s_cmp_eq_u64 s[14:15], 0
    s_cbranch_scc1 L_xsp_35
    s_waitcnt vmcnt(12)
    s_bfm_b64 exec, 16, 48
    v_cmp_ne_u64 vcc, v[12:13], v[2:3]
    s_mov_b64 exec, -1
    s_cbranch_vccz L_xsp_35
    s_mov_b32 s88, 0
    s_bfm_b64 exec, 16, 48
L_spin_36:
    buffer_load_dwordx2 v[12:13], v9, s[48:51], 0 offen sc1
    s_waitcnt vmcnt(0)
    v_cmp_ne_u64 vcc, v[12:13], v[2:3]
    s_cbranch_vccz L_spun_37
    s_add_u32 s88, s88, 1
    s_cmp_lt_u32 s88, 262144
    s_cbranch_scc1 L_spin_36
L_spun_37:
    s_mov_b64 exec, -1
L_xsp_35:
    s_barrier
    buffer_load_dwordx4 v[64:67], v1, s[48:51], s64 offen offset:0 sc1
    buffer_load_dwordx4 v[68:71], v1, s[48:51], s64 offen offset:1024 sc1
    buffer_load_dwordx4 v[72:75], v1, s[48:51], s64 offen offset:2048 sc1
    buffer_load_dwordx4 v[76:79], v1, s[48:51], s64 offen offset:3072 sc1
    s_add_u32 s64, s64, 4096
    buffer_load_dwordx4 v[80:83], v1, s[48:51], s64 offen offset:0 sc1
    buffer_load_dwordx4 v[84:87], v1, s[48:51], s64 offen offset:1024 sc1
    buffer_load_dwordx4 v[88:91], v1, s[48:51], s64 offen offset:2048 sc1
    buffer_load_dwordx4 v[92:95], v1, s[48:51], s64 offen offset:3072 sc1
    s_add_u32 s64, s64, 4096
    buffer_load_dwordx4 v[96:99], v1, s[48:51], s64 offen offset:0 sc1
    buffer_load_dwordx4 v[100:103], v1, s[48:51], s64 offen offset:1024 sc1
    buffer_load_dwordx4 v[104:107], v1, s[48:51], s64 offen offset:2048 sc1
    buffer_load_dwordx4 v[108:111], v1, s[48:51], s64 offen offset:3072 sc1
    s_waitcnt vmcnt(12)
    s_cmp_eq_u32 s90, 0
    s_cbranch_scc1 L_np2_38
    s_mov_b64 exec, 1
    buffer_store_dwordx2 v[2:3], off, s[48:51], s90 sc1
    s_mov_b64 exec, -1
L_np2_38:
    s_barrier
    v_mov_b32 v4, v1
    v_add_u32 v5, 0x10000, v1
    v_add_u32 v6, 0x20000, v1
    s_bitcmp1_b32 s55, 0
    s_cbranch_scc1 L_bY_39
    ds_read_b128 a[0:3], v4 offset:0
    ds_read_b128 a[4:7], v4 offset:1024
    ds_read_b128 a[8:11], v4 offset:3072
    ds_read_b128 a[12:15], v4 offset:4096
    ds_read_b128 a[16:19], v4 offset:6144
    ds_read_b128 a[20:23], v4 offset:7168
    s_waitcnt vmcnt(8)
    s_waitcnt lgkmcnt(5)
    v_mfma_f32_32x32x16_bf16 v[16:31], a[0:3], v[64:67], 0
    s_add_u32 s64, s64, 4096
    buffer_load_dwordx4 v[112:115], v1, s[48:51], s64 offen offset:0 sc1
    s_lshl_b32 s57, s54, 2
    s_add_u32 s57, s57, s3
    ds_read_b128 a[24:27], v4 offset:9216
    s_waitcnt lgkmcnt(5)
    v_mfma_f32_32x32x16_bf16 v[32:47], a[4:7], v[64:67], 0
    s_mul_i32 s56, s57, 48
    s_lshr_b32 s63, s55, 1
    ds_read_b128 a[28:31], v4 offset:10240
    s_waitcnt lgkmcnt(5)
    v_mfma_f32_32x32x16_bf16 v[16:31], a[8:11], v[68:71], v[16:31]
    buffer_load_dwordx4 v[116:119], v1, s[48:51], s64 offen offset:1024 sc1
    s_mul_i32 s58, s63, 6
    s_add_u32 s56, s56, s58
    ds_read_b128 a[0:3], v4 offset:12288
    s_waitcnt lgkmcnt(5)
    v_mfma_f32_32x32x16_bf16 v[32:47], a[12:15], v[68:71], v[32:47]
    s_lshl_b32 s56, s56, 10
    s_add_u32 s60, s56, 8388608
    ds_read_b128 a[4:7], v4 offset:13312
    s_waitcnt lgkmcnt(5)
    v_mfma_f32_32x32x16_bf16 v[16:31], a[16:19], v[72:75], v[16:31]
    buffer_load_dwordx4 v[120:123], v1, s[48:51], s64 offen offset:2048 sc1
    s_lshl_b32 s57, s57, 4
    s_add_u32 s57, s57, s55
    ds_read_b128 a[8:11], v4 offset:15360
    s_waitcnt lgkmcnt(5)
    v_mfma_f32_32x32x16_bf16 v[32:47], a[20:23], v[72:75], v[32:47]
    s_lshl_b32 s57, s57, 3
    s_add_u32 s89, s57, 19550208
    ds_read_b128 a[12:15], v4 offset:16384
    s_waitcnt lgkmcnt(5)
    v_mfma_f32_32x32x16_bf16 v[16:31], a[24:27], v[76:79], v[16:31]
    buffer_load_dwordx4 v[124:127], v1, s[48:51], s64 offen offset:3072 sc1
    s_lshr_b32 s58, s54, 3
    s_mul_i32 s56, s58, 24
    ds_read_b128 a[16:19], v4 offset:18432
    s_waitcnt lgkmcnt(5)
    v_mfma_f32_32x32x16_bf16 v[32:47], a[28:31], v[76:79], v[32:47]
    s_mul_i32 s57, s63, 3
    s_add_u32 s56, s56, s57
    ds_read_b128 a[20:23], v4 offset:19456
    s_waitcnt vmcnt(8)
    s_waitcnt lgkmcnt(5)
    v_mfma_f32_32x32x16_bf16 v[16:31], a[0:3], v[80:83], v[16:31]
    s_add_u32 s64, s64, 4096
    buffer_load_dwordx4 v[128:131], v1, s[48:51], s64 offen offset:0 sc1
    s_lshl_b32 s56, s56, 6
    s_and_b32 s57, s54, 7
    ds_read_b128 a[24:27], v4 offset:21504
    s_waitcnt lgkmcnt(5)
    v_mfma_f32_32x32x16_bf16 v[32:47], a[4:7], v[80:83], v[32:47]
    s_lshl_b32 s61, s57, 3
    s_add_u32 s56, s56, s61
    ds_read_b128 a[28:31], v4 offset:22528
    s_waitcnt lgkmcnt(5)
    v_mfma_f32_32x32x16_bf16 v[16:31], a[8:11], v[84:87], v[16:31]
    buffer_load_dwordx4 v[132:135], v1, s[48:51], s64 offen offset:1024 sc1
    s_lshl_b32 s61, s3, 1
    s_add_u32 s56, s56, s61
    ds_read_b128 a[0:3], v4 offset:24576
    s_waitcnt lgkmcnt(5)
    v_mfma_f32_32x32x16_bf16 v[32:47], a[12:15], v[84:87], v[32:47]
    s_lshl_b32 s56, s56, 10
    s_add_u32 s61, s56, 11534336
    ds_read_b128 a[4:7], v4 offset:25600
    s_waitcnt lgkmcnt(5)
    v_mfma_f32_32x32x16_bf16 v[16:31], a[16:19], v[88:91], v[16:31]
    buffer_load_dwordx4 v[136:139], v1, s[48:51], s64 offen offset:2048 sc1
    s_lshl_b32 s58, s58, 3
    s_add_u32 s58, s58, s63
    ds_read_b128 a[8:11], v4 offset:27648
    s_waitcnt lgkmcnt(5)
    v_mfma_f32_32x32x16_bf16 v[32:47], a[20:23], v[88:91], v[32:47]
    s_lshl_b32 s58, s58, 6
    s_lshl_b32 s57, s57, 2
    ds_read_b128 a[12:15], v4 offset:28672
    s_waitcnt lgkmcnt(5)
    v_mfma_f32_32x32x16_bf16 v[16:31], a[24:27], v[92:95], v[16:31]
    buffer_load_dwordx4 v[140:143], v1, s[48:51], s64 offen offset:3072 sc1
    s_add_u32 s58, s58, s57
    s_add_u32 s58, s58, s3
    ds_read_b128 a[16:19], v4 offset:30720
    s_waitcnt lgkmcnt(5)
    v_mfma_f32_32x32x16_bf16 v[32:47], a[28:31], v[92:95], v[32:47]
    s_lshl_b32 s58, s58, 3
    s_add_u32 s59, s58, 19558400
    ds_read_b128 a[20:23], v4 offset:31744
    s_waitcnt vmcnt(8)
    s_waitcnt lgkmcnt(5)
    v_mfma_f32_32x32x16_bf16 v[16:31], a[0:3], v[96:99], v[16:31]
    s_add_u32 s64, s64, 4096
    buffer_load_dwordx4 v[144:147], v1, s[48:51], s64 offen offset:0 sc1
    ds_read_b128 a[24:27], v4 offset:33792
    s_waitcnt lgkmcnt(5)
    v_mfma_f32_32x32x16_bf16 v[32:47], a[4:7], v[96:99], v[32:47]
    ds_read_b128 a[28:31], v4 offset:34816
    s_waitcnt lgkmcnt(5)
    v_mfma_f32_32x32x16_bf16 v[16:31], a[8:11], v[100:103], v[16:31]
    buffer_load_dwordx4 v[148:151], v1, s[48:51], s64 offen offset:1024 sc1
    ds_read_b128 a[0:3], v4 offset:36864
    s_waitcnt lgkmcnt(5)
    v_mfma_f32_32x32x16_bf16 v[32:47], a[12:15], v[100:103], v[32:47]
    ds_read_b128 a[4:7], v4 offset:37888
    s_waitcnt lgkmcnt(5)
    v_mfma_f32_32x32x16_bf16 v[16:31], a[16:19], v[104:107], v[16:31]
    buffer_load_dwordx4 v[152:155], v1, s[48:51], s64 offen offset:2048 sc1
    ds_read_b128 a[8:11], v4 offset:39936
    s_waitcnt lgkmcnt(5)
    v_mfma_f32_32x32x16_bf16 v[32:47], a[20:23], v[104:107], v[32:47]
    ds_read_b128 a[12:15], v4 offset:40960
    s_waitcnt lgkmcnt(5)
    v_mfma_f32_32x32x16_bf16 v[16:31], a[24:27], v[108:111], v[16:31]
    buffer_load_dwordx4 v[156:159], v1, s[48:51], s64 offen offset:3072 sc1
    ds_read_b128 a[16:19], v4 offset:43008
    s_waitcnt lgkmcnt(5)
    v_mfma_f32_32x32x16_bf16 v[32:47], a[28:31], v[108:111], v[32:47]
    ds_read_b128 a[20:23], v4 offset:44032
    s_waitcnt vmcnt(8)
    s_waitcnt lgkmcnt(5)
    v_mfma_f32_32x32x16_bf16 v[16:31], a[0:3], v[112:115], v[16:31]
    s_add_u32 s64, s64, 4096
    buffer_load_dwordx4 v[160:163], v1, s[48:51], s64 offen offset:0 sc1
    ds_read_b128 a[24:27], v4 offset:46080
    s_waitcnt lgkmcnt(5)
    v_mfma_f32_32x32x16_bf16 v[32:47], a[4:7], v[112:115], v[32:47]
    ds_read_b128 a[28:31], v4 offset:47104
    s_waitcnt lgkmcnt(5)
    v_mfma_f32_32x32x16_bf16 v[16:31], a[8:11], v[116:119], v[16:31]
    buffer_load_dwordx4 v[164:167], v1, s[48:51], s64 offen offset:1024 sc1
    ds_read_b128 a[0:3], v4 offset:49152
    s_waitcnt lgkmcnt(5)
    v_mfma_f32_32x32x16_bf16 v[32:47], a[12:15], v[116:119], v[32:47]
    ds_read_b128 a[4:7], v4 offset:50176
    s_waitcnt lgkmcnt(5)
    v_mfma_f32_32x32x16_bf16 v[16:31], a[16:19], v[120:123], v[16:31]
    buffer_load_dwordx4 v[168:171], v1, s[48:51], s64 offen offset:2048 sc1
    ds_read_b128 a[8:11], v4 offset:52224
    s_waitcnt lgkmcnt(5)
    v_mfma_f32_32x32x16_bf16 v[32:47], a[20:23], v[120:123], v[32:47]
    ds_read_b128 a[12:15], v4 offset:53248
    s_waitcnt lgkmcnt(5)
    v_mfma_f32_32x32x16_bf16 v[16:31], a[24:27], v[124:127], v[16:31]
    buffer_load_dwordx4 v[172:175], v1, s[48:51], s64 offen offset:3072 sc1
    ds_read_b128 a[16:19], v4 offset:55296
    s_waitcnt lgkmcnt(5)
    v_mfma_f32_32x32x16_bf16 v[32:47], a[28:31], v[124:127], v[32:47]
    ds_read_b128 a[20:23], v4 offset:56320
    s_waitcnt vmcnt(8)
    s_waitcnt lgkmcnt(5)
    v_mfma_f32_32x32x16_bf16 v[16:31], a[0:3], v[128:131], v[16:31]
    s_add_u32 s64, s64, 4096
    buffer_load_dwordx4 v[176:179], v1, s[48:51], s64 offen offset:0 sc1
    ds_read_b128 a[24:27], v4 offset:58368
    s_waitcnt lgkmcnt(5)
    v_mfma_f32_32x32x16_bf16 v[32:47], a[4:7], v[128:131], v[32:47]
    ds_read_b128 a[28:31], v4 offset:59392
    s_waitcnt lgkmcnt(5)
    v_mfma_f32_32x32x16_bf16 v[16:31], a[8:11], v[132:135], v[16:31]
    buffer_load_dwordx4 v[180:183], v1, s[48:51], s64 offen offset:1024 sc1
    ds_read_b128 a[0:3], v4 offset:61440
    s_waitcnt lgkmcnt(5)
    v_mfma_f32_32x32x16_bf16 v[32:47], a[12:15], v[132:135], v[32:47]
    ds_read_b128 a[4:7], v4 offset:62464
    s_waitcnt lgkmcnt(5)
    v_mfma_f32_32x32x16_bf16 v[16:31], a[16:19], v[136:139], v[16:31]
    buffer_load_dwordx4 v[184:187], v1, s[48:51], s64 offen offset:2048 sc1
    ds_read_b128 a[8:11], v4 offset:64512
    s_waitcnt lgkmcnt(5)
    v_mfma_f32_32x32x16_bf16 v[32:47], a[20:23], v[136:139], v[32:47]
    ds_read_b128 a[12:15], v5 offset:0
    s_waitcnt lgkmcnt(5)
    v_mfma_f32_32x32x16_bf16 v[16:31], a[24:27], v[140:143], v[16:31]
    buffer_load_dwordx4 v[188:191], v1, s[48:51], s64 offen offset:3072 sc1
    ds_read_b128 a[16:19], v5 offset:2048
    s_waitcnt lgkmcnt(5)
    v_mfma_f32_32x32x16_bf16 v[32:47], a[28:31], v[140:143], v[32:47]
    s_mov_b64 exec, s[12:13]
    buffer_load_dwordx2 v[12:13], v10, s[48:51], 0 offen sc1
    s_mov_b64 exec, -1
    ds_read_b128 a[20:23], v5 offset:3072
    s_waitcnt vmcnt(9)
    s_waitcnt lgkmcnt(5)
    v_mfma_f32_32x32x16_bf16 v[16:31], a[0:3], v[144:147], v[16:31]
    s_add_u32 s64, s64, 4096
    buffer_load_dwordx4 v[192:195], v1, s[48:51], s64 offen offset:0 sc1
    ds_read_b128 a[24:27], v5 offset:5120
    s_waitcnt lgkmcnt(5)
    v_mfma_f32_32x32x16_bf16 v[32:47], a[4:7], v[144:147], v[32:47]
    ds_read_b128 a[28:31], v5 offset:6144
    s_waitcnt lgkmcnt(5)
    v_mfma_f32_32x32x16_bf16 v[16:31], a[8:11], v[148:151], v[16:31]
    buffer_load_dwordx4 v[196:199], v1, s[48:51], s64 offen offset:1024 sc1
    ds_read_b128 a[0:3], v5 offset:8192
    s_waitcnt lgkmcnt(5)
    v_mfma_f32_32x32x16_bf16 v[32:47], a[12:15], v[148:151], v[32:47]
    ds_read_b128 a[4:7], v5 offset:9216
    s_waitcnt lgkmcnt(5)
    v_mfma_f32_32x32x16_bf16 v[16:31], a[16:19], v[152:155], v[16:31]
    buffer_load_dwordx4 v[200:203], v1, s[48:51], s64 offen offset:2048 sc1
    ds_read_b128 a[8:11], v5 offset:11264
    s_waitcnt lgkmcnt(5)
    v_mfma_f32_32x32x16_bf16 v[32:47], a[20:23], v[152:155], v[32:47]
    ds_read_b128 a[12:15], v5 offset:12288
    s_waitcnt lgkmcnt(5)
    v_mfma_f32_32x32x16_bf16 v[16:31], a[24:27], v[156:159], v[16:31]
    buffer_load_dwordx4 v[204:207], v1, s[48:51], s64 offen offset:3072 sc1
    ds_read_b128 a[16:19], v5 offset:14336
    s_waitcnt lgkmcnt(5)
    v_mfma_f32_32x32x16_bf16 v[32:47], a[28:31], v[156:159], v[32:47]
    ds_read_b128 a[20:23], v5 offset:15360
    s_waitcnt vmcnt(9)
    s_waitcnt lgkmcnt(5)
    v_mfma_f32_32x32x16_bf16 v[16:31], a[0:3], v[160:163], v[16:31]
    s_add_u32 s64, s64, 4096
    buffer_load_dwordx4 v[208:211], v1, s[48:51], s64 offen offset:0 sc1
    ds_read_b128 a[24:27], v5 offset:17408
    s_waitcnt lgkmcnt(5)
    v_mfma_f32_32x32x16_bf16 v[32:47], a[4:7], v[160:163], v[32:47]
    ds_read_b128 a[28:31], v5 offset:18432
    s_waitcnt lgkmcnt(5)
    v_mfma_f32_32x32x16_bf16 v[16:31], a[8:11], v[164:167], v[16:31]
    buffer_load_dwordx4 v[212:215], v1, s[48:51], s64 offen offset:1024 sc1
    ds_read_b128 a[0:3], v5 offset:20480
    s_waitcnt lgkmcnt(5)
    v_mfma_f32_32x32x16_bf16 v[32:47], a[12:15], v[164:167], v[32:47]
    ds_read_b128 a[4:7], v5 offset:21504
    s_waitcnt lgkmcnt(5)
    v_mfma_f32_32x32x16_bf16 v[16:31], a[16:19], v[168:171], v[16:31]
    buffer_load_dwordx4 v[216:219], v1, s[48:51], s64 offen offset:2048 sc1
    ds_read_b128 a[8:11], v5 offset:23552
    s_waitcnt lgkmcnt(5)
    v_mfma_f32_32x32x16_bf16 v[32:47], a[20:23], v[168:171], v[32:47]
    ds_read_b128 a[12:15], v5 offset:24576
    s_waitcnt lgkmcnt(5)
    v_mfma_f32_32x32x16_bf16 v[16:31], a[24:27], v[172:175], v[16:31]
    buffer_load_dwordx4 v[220:223], v1, s[48:51], s64 offen offset:3072 sc1
    ds_read_b128 a[16:19], v5 offset:26624
    s_waitcnt lgkmcnt(5)
    v_mfma_f32_32x32x16_bf16 v[32:47], a[28:31], v[172:175], v[32:47]
    ds_read_b128 a[20:23], v5 offset:27648
    s_waitcnt vmcnt(9)
    s_waitcnt lgkmcnt(5)
    v_mfma_f32_32x32x16_bf16 v[16:31], a[0:3], v[176:179], v[16:31]
    s_add_u32 s64, s64, 4096
    buffer_load_dwordx4 v[224:227], v1, s[48:51], s64 offen offset:0 sc1
    ds_read_b128 a[24:27], v5 offset:29696
    s_waitcnt lgkmcnt(5)
    v_mfma_f32_32x32x16_bf16 v[32:47], a[4:7], v[176:179], v[32:47]
    ds_read_b128 a[28:31], v5 offset:30720
    s_waitcnt lgkmcnt(5)
    v_mfma_f32_32x32x16_bf16 v[16:31], a[8:11], v[180:183], v[16:31]
    buffer_load_dwordx4 v[228:231], v1, s[48:51], s64 offen offset:1024 sc1
    ds_read_b128 a[0:3], v5 offset:32768
    s_waitcnt lgkmcnt(5)
    v_mfma_f32_32x32x16_bf16 v[32:47], a[12:15], v[180:183], v[32:47]
    ds_read_b128 a[4:7], v5 offset:33792
    s_waitcnt lgkmcnt(5)
    v_mfma_f32_32x32x16_bf16 v[16:31], a[16:19], v[184:187], v[16:31]
    buffer_load_dwordx4 v[232:235], v1, s[48:51], s64 offen offset:2048 sc1
    ds_read_b128 a[8:11], v5 offset:35840
    s_waitcnt lgkmcnt(5)
    v_mfma_f32_32x32x16_bf16 v[32:47], a[20:23], v[184:187], v[32:47]
    ds_read_b128 a[12:15], v5 offset:36864
    s_waitcnt lgkmcnt(5)
    v_mfma_f32_32x32x16_bf16 v[16:31], a[24:27], v[188:191], v[16:31]
    buffer_load_dwordx4 v[236:239], v1, s[48:51], s64 offen offset:3072 sc1
    ds_read_b128 a[16:19], v5 offset:38912
    s_waitcnt lgkmcnt(5)
    v_mfma_f32_32x32x16_bf16 v[32:47], a[28:31], v[188:191], v[32:47]
    ds_read_b128 a[20:23], v5 offset:39936
    s_waitcnt vmcnt(8)
    s_waitcnt lgkmcnt(5)
    v_mfma_f32_32x32x16_bf16 v[16:31], a[0:3], v[192:195], v[16:31]
    s_add_u32 s64, s64, 4096
    buffer_load_dwordx4 v[240:243], v1, s[48:51], s64 offen offset:0 sc1
    ds_read_b128 a[24:27], v5 offset:41984
    s_waitcnt lgkmcnt(5)
    v_mfma_f32_32x32x16_bf16 v[32:47], a[4:7], v[192:195], v[32:47]
    ds_read_b128 a[28:31], v5 offset:43008
    s_waitcnt lgkmcnt(5)
    v_mfma_f32_32x32x16_bf16 v[16:31], a[8:11], v[196:199], v[16:31]
    buffer_load_dwordx4 v[244:247], v1, s[48:51], s64 offen offset:1024 sc1
    ds_read_b128 a[0:3], v5 offset:45056
    s_waitcnt lgkmcnt(5)
    v_mfma_f32_32x32x16_bf16 v[32:47], a[12:15], v[196:199], v[32:47]
    ds_read_b128 a[4:7], v5 offset:46080
    s_waitcnt lgkmcnt(5)
    v_mfma_f32_32x32x16_bf16 v[16:31], a[16:19], v[200:203], v[16:31]
    buffer_load_dwordx4 v[248:251], v1, s[48:51], s64 offen offset:2048 sc1
    ds_read_b128 a[8:11], v5 offset:48128
    s_waitcnt lgkmcnt(5)
    v_mfma_f32_32x32x16_bf16 v[32:47], a[20:23], v[200:203], v[32:47]
    ds_read_b128 a[12:15], v5 offset:49152
    s_waitcnt lgkmcnt(5)
    v_mfma_f32_32x32x16_bf16 v[16:31], a[24:27], v[204:207], v[16:31]
    buffer_load_dwordx4 v[252:255], v1, s[48:51], s64 offen offset:3072 sc1
    ds_read_b128 a[16:19], v5 offset:51200
    s_waitcnt lgkmcnt(5)
    v_mfma_f32_32x32x16_bf16 v[32:47], a[28:31], v[204:207], v[32:47]
    s_mov_b64 exec, s[12:13]
    v_cmp_ne_u64 vcc, v[12:13], v[2:3]
    s_cbranch_vccz L_w2ok_41
    s_mov_b32 s88, 0
    s_mov_b64 exec, s[12:13]
L_spin_42:
    buffer_load_dwordx2 v[12:13], v10, s[48:51], 0 offen sc1
    s_waitcnt vmcnt(0)
    v_cmp_ne_u64 vcc, v[12:13], v[2:3]
    s_cbranch_vccz L_spun_43
    s_add_u32 s88, s88, 1
    s_cmp_lt_u32 s88, 262144
    s_cbranch_scc1 L_spin_42
L_spun_43:
    s_mov_b64 exec, -1
L_w2ok_41:
    s_mov_b64 exec, -1
    ds_read_b128 a[20:23], v5 offset:52224
    s_waitcnt vmcnt(8)
    s_waitcnt lgkmcnt(5)
    v_mfma_f32_32x32x16_bf16 v[16:31], a[0:3], v[208:211], v[16:31]
    s_add_u32 s67, s69, 0
    s_add_u32 m0, s66, 0
    s_nop 0
    buffer_load_dwordx4 v1, s[48:51], s67 offen offset:2048 sc1 lds
    ds_read_b128 a[24:27], v5 offset:54272
    s_waitcnt lgkmcnt(5)
    v_mfma_f32_32x32x16_bf16 v[32:47], a[4:7], v[208:211], v[32:47]
    ds_read_b128 a[28:31], v5 offset:55296
    s_waitcnt lgkmcnt(5)
    v_mfma_f32_32x32x16_bf16 v[16:31], a[8:11], v[212:215], v[16:31]
    s_add_u32 s67, s69, 12288
    s_add_u32 m0, s66, 12288
    s_nop 0
    buffer_load_dwordx4 v1, s[48:51], s67 offen offset:2048 sc1 lds
    ds_read_b128 a[0:3], v5 offset:57344
    s_waitcnt lgkmcnt(5)
    v_mfma_f32_32x32x16_bf16 v[32:47], a[12:15], v[212:215], v[32:47]
    ds_read_b128 a[4:7], v5 offset:58368
    s_waitcnt lgkmcnt(5)
    v_mfma_f32_32x32x16_bf16 v[16:31], a[16:19], v[216:219], v[16:31]
    s_add_u32 s67, s69, 24576
    s_add_u32 m0, s66, 24576
    s_nop 0
    buffer_load_dwordx4 v1, s[48:51], s67 offen offset:2048 sc1 lds
    ds_read_b128 a[8:11], v5 offset:60416
    s_waitcnt lgkmcnt(5)
    v_mfma_f32_32x32x16_bf16 v[32:47], a[20:23], v[216:219], v[32:47]
    ds_read_b128 a[12:15], v5 offset:61440
    s_waitcnt lgkmcnt(5)
    v_mfma_f32_32x32x16_bf16 v[16:31], a[24:27], v[220:223], v[16:31]
    s_add_u32 s67, s69, 36864
    s_add_u32 m0, s66, 36864
    s_nop 0
    buffer_load_dwordx4 v1, s[48:51], s67 offen offset:2048 sc1 lds
    ds_read_b128 a[16:19], v5 offset:63488
    s_waitcnt lgkmcnt(5)
    v_mfma_f32_32x32x16_bf16 v[32:47], a[28:31], v[220:223], v[32:47]
    ds_read_b128 a[20:23], v5 offset:64512
    s_waitcnt vmcnt(8)
    s_waitcnt lgkmcnt(5)
    v_mfma_f32_32x32x16_bf16 v[16:31], a[0:3], v[224:227], v[16:31]
    s_add_u32 s67, s69, 49152
    s_add_u32 m0, s66, 49152
    s_nop 0
    buffer_load_dwordx4 v1, s[48:51], s67 offen offset:2048 sc1 lds
    ds_read_b128 a[24:27], v6 offset:1024
    s_waitcnt lgkmcnt(5)
    v_mfma_f32_32x32x16_bf16 v[32:47], a[4:7], v[224:227], v[32:47]
    ds_read_b128 a[28:31], v6 offset:2048
    s_waitcnt lgkmcnt(5)
    v_mfma_f32_32x32x16_bf16 v[16:31], a[8:11], v[228:231], v[16:31]
    s_add_u32 s67, s69, 61440
    s_add_u32 m0, s66, 61440
    s_nop 0
    buffer_load_dwordx4 v1, s[48:51], s67 offen offset:2048 sc1 lds
    ds_read_b128 a[0:3], v6 offset:4096
    s_waitcnt lgkmcnt(5)
    v_mfma_f32_32x32x16_bf16 v[32:47], a[12:15], v[228:231], v[32:47]
    ds_read_b128 a[4:7], v6 offset:5120
    s_waitcnt lgkmcnt(5)
    v_mfma_f32_32x32x16_bf16 v[16:31], a[16:19], v[232:235], v[16:31]
    s_add_u32 s67, s69, 73728
    s_add_u32 m0, s66, 73728
    s_nop 0
    buffer_load_dwordx4 v1, s[48:51], s67 offen offset:2048 sc1 lds
    ds_read_b128 a[8:11], v6 offset:7168
    s_waitcnt lgkmcnt(5)
    v_mfma_f32_32x32x16_bf16 v[32:47], a[20:23], v[232:235], v[32:47]
    ds_read_b128 a[12:15], v6 offset:8192
    s_waitcnt lgkmcnt(5)
    v_mfma_f32_32x32x16_bf16 v[16:31], a[24:27], v[236:239], v[16:31]
    s_add_u32 s67, s69, 86016
    s_add_u32 m0, s66, 86016
    s_nop 0
    buffer_load_dwordx4 v1, s[48:51], s67 offen offset:2048 sc1 lds
    ds_read_b128 a[16:19], v6 offset:10240
    s_waitcnt lgkmcnt(5)
    v_mfma_f32_32x32x16_bf16 v[32:47], a[28:31], v[236:239], v[32:47]
    ds_read_b128 a[20:23], v6 offset:11264
    s_waitcnt vmcnt(8)
    s_waitcnt lgkmcnt(5)
    v_mfma_f32_32x32x16_bf16 v[16:31], a[0:3], v[240:243], v[16:31]
    s_add_u32 s67, s69, 98304
    s_add_u32 m0, s66, 98304
    s_nop 0
    buffer_load_dwordx4 v1, s[48:51], s67 offen offset:2048 sc1 lds
    ds_read_b128 a[24:27], v6 offset:13312
    s_waitcnt lgkmcnt(5)
    v_mfma_f32_32x32x16_bf16 v[32:47], a[4:7], v[240:243], v[32:47]
    ds_read_b128 a[28:31], v6 offset:14336
    s_waitcnt lgkmcnt(5)
    v_mfma_f32_32x32x16_bf16 v[16:31], a[8:11], v[244:247], v[16:31]
    s_add_u32 s67, s69, 110592
    s_add_u32 m0, s66, 110592
    s_nop 0
    buffer_load_dwordx4 v1, s[48:51], s67 offen offset:2048 sc1 lds
    s_waitcnt lgkmcnt(4)
    v_mfma_f32_32x32x16_bf16 v[32:47], a[12:15], v[244:247], v[32:47]
    s_waitcnt lgkmcnt(3)
    v_mfma_f32_32x32x16_bf16 v[16:31], a[16:19], v[248:251], v[16:31]
    s_add_u32 s67, s69, 122880
    s_add_u32 m0, s66, 122880
    s_nop 0
    buffer_load_dwordx4 v1, s[48:51], s67 offen offset:2048 sc1 lds
    s_waitcnt lgkmcnt(2)
    v_mfma_f32_32x32x16_bf16 v[32:47], a[20:23], v[248:251], v[32:47]
    s_waitcnt lgkmcnt(1)
    v_mfma_f32_32x32x16_bf16 v[16:31], a[24:27], v[252:255], v[16:31]
    s_add_u32 s67, s69, 135168
    s_add_u32 m0, s66, 135168
    s_nop 0
    buffer_load_dwordx4 v1, s[48:51], s67 offen offset:2048 sc1 lds
    s_waitcnt lgkmcnt(0)
    v_mfma_f32_32x32x16_bf16 v[32:47], a[28:31], v[252:255], v[32:47]
    s_nop 5
    v_cvt_pk_bf16_f32 v16, v16, v17
    v_cvt_pk_bf16_f32 v17, v18, v19
    v_cvt_pk_bf16_f32 v18, v20, v21
    v_cvt_pk_bf16_f32 v19, v22, v23
    buffer_store_dwordx4 v[16:19], v1, s[48:51], s60 offen offset:0 sc1
    v_cvt_pk_bf16_f32 v24, v24, v25
    v_cvt_pk_bf16_f32 v25, v26, v27
    v_cvt_pk_bf16_f32 v26, v28, v29
    v_cvt_pk_bf16_f32 v27, v30, v31
    buffer_store_dwordx4 v[24:27], v1, s[48:51], s60 offen offset:1024 sc1
    v_cvt_pk_bf16_f32 v32, v32, v33
    v_cvt_pk_bf16_f32 v33, v34, v35
    v_cvt_pk_bf16_f32 v34, v36, v37
    v_cvt_pk_bf16_f32 v35, v38, v39
    buffer_store_dwordx4 v[32:35], v1, s[48:51], s60 offen offset:2048 sc1
    v_cvt_pk_bf16_f32 v40, v40, v41
    v_cvt_pk_bf16_f32 v41, v42, v43
    v_cvt_pk_bf16_f32 v42, v44, v45
    v_cvt_pk_bf16_f32 v43, v46, v47
    buffer_store_dwordx4 v[40:43], v1, s[48:51], s60 offen offset:3072 sc1
    s_waitcnt vmcnt(8)
    s_barrier
    ds_read_b128 a[0:3], v4 offset:2048
    ds_read_b128 a[4:7], v4 offset:5120
    ds_read_b128 a[8:11], v4 offset:8192
    ds_read_b128 a[12:15], v4 offset:11264
    ds_read_b128 a[16:19], v4 offset:14336
    ds_read_b128 a[20:23], v4 offset:17408
    s_waitcnt lgkmcnt(5)
    v_mfma_f32_32x32x16_bf16 v[48:63], v[64:67], a[0:3], 0
    s_lshr_b32 s56, s52, 2
    s_lshl_b32 s56, s56, 4
    ds_read_b128 a[24:27], v4 offset:20480
    s_waitcnt lgkmcnt(5)
    v_mfma_f32_32x32x16_bf16 v[48:63], v[68:71], a[4:7], v[48:63]
    s_and_b32 s57, s52, 1
    s_xor_b32 s57, s57, 1
    ds_read_b128 a[28:31], v4 offset:23552
    s_waitcnt lgkmcnt(5)
    v_mfma_f32_32x32x16_bf16 v[48:63], v[72:75], a[8:11], v[48:63]
    s_lshl_b32 s57, s57, 3
    s_add_u32 s56, s56, s57
    ds_read_b128 a[0:3], v4 offset:26624
    s_waitcnt lgkmcnt(5)
    v_mfma_f32_32x32x16_bf16 v[48:63], v[76:79], a[12:15], v[48:63]
    s_and_b32 s57, s53, 7
    s_add_u32 s56, s56, s57
    ds_read_b128 a[4:7], v4 offset:29696
    s_waitcnt lgkmcnt(5)
    v_mfma_f32_32x32x16_bf16 v[48:63], v[80:83], a[16:19], v[48:63]
    s_mul_i32 s56, s56, 98304
    s_lshr_b32 s57, s52, 1
    ds_read_b128 a[8:11], v4 offset:32768
    s_waitcnt lgkmcnt(5)
    v_mfma_f32_32x32x16_bf16 v[48:63], v[84:87], a[20:23], v[48:63]
    s_and_b32 s57, s57, 1
    s_lshl_b32 s57, s57, 2
    ds_read_b128 a[12:15], v4 offset:35840
    s_waitcnt lgkmcnt(5)
    v_mfma_f32_32x32x16_bf16 v[48:63], v[88:91], a[24:27], v[48:63]
    s_lshr_b32 s58, s53, 3
    s_add_u32 s57, s57, s58
    ds_read_b128 a[16:19], v4 offset:38912
    s_waitcnt lgkmcnt(5)
    v_mfma_f32_32x32x16_bf16 v[48:63], v[92:95], a[28:31], v[48:63]
    s_mul_i32 s57, s57, 192
    s_add_u32 s56, s56, s57
    ds_read_b128 a[20:23], v4 offset:41984
    s_waitcnt lgkmcnt(5)
    v_mfma_f32_32x32x16_bf16 v[48:63], v[96:99], a[0:3], v[48:63]
    v_lshrrev_b32 v14, 3, v0
    s_lshl_b32 s57, s3, 3
    ds_read_b128 a[24:27], v4 offset:45056
    s_waitcnt lgkmcnt(5)
    v_mfma_f32_32x32x16_bf16 v[48:63], v[100:103], a[4:7], v[48:63]
    v_add_u32 v14, s57, v14
    v_mul_u32_u24 v14, 1536, v14
    ds_read_b128 a[28:31], v4 offset:48128
    s_waitcnt lgkmcnt(5)
    v_mfma_f32_32x32x16_bf16 v[48:63], v[104:107], a[8:11], v[48:63]
    v_and_b32 v15, 7, v0
    v_lshl_add_u32 v14, v15, 3, v14
    ds_read_b128 a[0:3], v4 offset:51200
    s_waitcnt lgkmcnt(5)
    v_mfma_f32_32x32x16_bf16 v[48:63], v[108:111], a[12:15], v[48:63]
    buffer_load_dwordx2 a[220:221], v14, s[20:23], s56 offen offset:0
    buffer_load_dwordx2 a[222:223], v14, s[20:23], s56 offen offset:64
    ds_read_b128 a[4:7], v4 offset:54272
    s_waitcnt lgkmcnt(5)
    v_mfma_f32_32x32x16_bf16 v[48:63], v[112:115], a[16:19], v[48:63]
    buffer_load_dwordx2 a[224:225], v14, s[20:23], s56 offen offset:128
    s_add_u32 s56, s56, 49152
    ds_read_b128 a[8:11], v4 offset:57344
    s_waitcnt lgkmcnt(5)
    v_mfma_f32_32x32x16_bf16 v[48:63], v[116:119], a[20:23], v[48:63]
    buffer_load_dwordx2 a[226:227], v14, s[20:23], s56 offen offset:0
    buffer_load_dwordx2 a[228:229], v14, s[20:23], s56 offen offset:64
    ds_read_b128 a[12:15], v4 offset:60416
    s_waitcnt lgkmcnt(5)
    v_mfma_f32_32x32x16_bf16 v[48:63], v[120:123], a[24:27], v[48:63]
    buffer_load_dwordx2 a[230:231], v14, s[20:23], s56 offen offset:128
    ds_read_b128 a[16:19], v4 offset:63488
    s_waitcnt lgkmcnt(5)
    v_mfma_f32_32x32x16_bf16 v[48:63], v[124:127], a[28:31], v[48:63]
    ds_read_b128 a[20:23], v5 offset:1024
    s_waitcnt lgkmcnt(5)
    v_mfma_f32_32x32x16_bf16 v[48:63], v[128:131], a[0:3], v[48:63]
    ds_read_b128 a[24:27], v5 offset:4096
    s_waitcnt lgkmcnt(5)
    v_mfma_f32_32x32x16_bf16 v[48:63], v[132:135], a[4:7], v[48:63]
    ds_read_b128 a[28:31], v5 offset:7168
    s_waitcnt lgkmcnt(5)
    v_mfma_f32_32x32x16_bf16 v[48:63], v[136:139], a[8:11], v[48:63]
    ds_read_b128 a[0:3], v5 offset:10240
    s_waitcnt lgkmcnt(5)
    v_mfma_f32_32x32x16_bf16 v[48:63], v[140:143], a[12:15], v[48:63]
    ds_read_b128 a[4:7], v5 offset:13312
    s_waitcnt lgkmcnt(5)
    v_mfma_f32_32x32x16_bf16 v[48:63], v[144:147], a[16:19], v[48:63]
    s_waitcnt vmcnt(6)
    s_mov_b64 exec, 1
    buffer_store_dwordx2 v[2:3], off, s[48:51], s89 sc1
    s_mov_b64 exec, -1
    s_mov_b32 s89, s59
    ds_read_b128 a[8:11], v5 offset:16384
    s_waitcnt lgkmcnt(5)
    v_mfma_f32_32x32x16_bf16 v[48:63], v[148:151], a[20:23], v[48:63]
    ds_read_b128 a[12:15], v5 offset:19456
    s_waitcnt lgkmcnt(5)
    v_mfma_f32_32x32x16_bf16 v[48:63], v[152:155], a[24:27], v[48:63]
    ds_read_b128 a[16:19], v5 offset:22528
    s_waitcnt lgkmcnt(5)
    v_mfma_f32_32x32x16_bf16 v[48:63], v[156:159], a[28:31], v[48:63]
    ds_read_b128 a[20:23], v5 offset:25600
    s_waitcnt lgkmcnt(5)
    v_mfma_f32_32x32x16_bf16 v[48:63], v[160:163], a[0:3], v[48:63]
    ds_read_b128 a[24:27], v5 offset:28672
    s_waitcnt lgkmcnt(5)
    v_mfma_f32_32x32x16_bf16 v[48:63], v[164:167], a[4:7], v[48:63]
    ds_read_b128 a[28:31], v5 offset:31744
    s_waitcnt lgkmcnt(5)
    v_mfma_f32_32x32x16_bf16 v[48:63], v[168:171], a[8:11], v[48:63]
    s_barrier
    ds_read_b128 a[0:3], v5 offset:34816
    s_waitcnt lgkmcnt(5)
    v_mfma_f32_32x32x16_bf16 v[48:63], v[172:175], a[12:15], v[48:63]
    ds_read_b128 a[4:7], v5 offset:37888
    s_waitcnt lgkmcnt(5)
    v_mfma_f32_32x32x16_bf16 v[48:63], v[176:179], a[16:19], v[48:63]
    ds_read_b128 a[8:11], v5 offset:40960
    s_waitcnt lgkmcnt(5)
    v_mfma_f32_32x32x16_bf16 v[48:63], v[180:183], a[20:23], v[48:63]
    ds_read_b128 a[12:15], v5 offset:44032
    s_waitcnt lgkmcnt(5)
    v_mfma_f32_32x32x16_bf16 v[48:63], v[184:187], a[24:27], v[48:63]
    ds_read_b128 a[16:19], v5 offset:47104
    s_waitcnt lgkmcnt(5)
    v_mfma_f32_32x32x16_bf16 v[48:63], v[188:191], a[28:31], v[48:63]
    ds_read_b128 a[20:23], v5 offset:50176
    s_waitcnt lgkmcnt(5)
    v_mfma_f32_32x32x16_bf16 v[48:63], v[192:195], a[0:3], v[48:63]
    ds_read_b128 a[24:27], v5 offset:53248
    s_waitcnt lgkmcnt(5)
    v_mfma_f32_32x32x16_bf16 v[48:63], v[196:199], a[4:7], v[48:63]
    ds_read_b128 a[28:31], v5 offset:56320
    s_waitcnt lgkmcnt(5)
    v_mfma_f32_32x32x16_bf16 v[48:63], v[200:203], a[8:11], v[48:63]
    ds_read_b128 a[0:3], v5 offset:59392
    s_waitcnt lgkmcnt(5)
    v_mfma_f32_32x32x16_bf16 v[48:63], v[204:207], a[12:15], v[48:63]
    ds_read_b128 a[4:7], v5 offset:62464
    s_waitcnt lgkmcnt(5)
    v_mfma_f32_32x32x16_bf16 v[48:63], v[208:211], a[16:19], v[48:63]
    ds_read_b128 a[8:11], v6 offset:0
    s_waitcnt lgkmcnt(5)
    v_mfma_f32_32x32x16_bf16 v[48:63], v[212:215], a[20:23], v[48:63]
    ds_read_b128 a[12:15], v6 offset:3072
    s_waitcnt lgkmcnt(5)
    v_mfma_f32_32x32x16_bf16 v[48:63], v[216:219], a[24:27], v[48:63]
    ds_read_b128 a[16:19], v6 offset:6144
    s_waitcnt lgkmcnt(5)
    v_mfma_f32_32x32x16_bf16 v[48:63], v[220:223], a[28:31], v[48:63]
    ds_read_b128 a[20:23], v6 offset:9216
    s_waitcnt lgkmcnt(5)
    v_mfma_f32_32x32x16_bf16 v[48:63], v[224:227], a[0:3], v[48:63]
    ds_read_b128 a[24:27], v6 offset:12288
    s_waitcnt lgkmcnt(5)
    v_mfma_f32_32x32x16_bf16 v[48:63], v[228:231], a[4:7], v[48:63]
    ds_read_b128 a[28:31], v6 offset:15360
    s_waitcnt lgkmcnt(5)
    v_mfma_f32_32x32x16_bf16 v[48:63], v[232:235], a[8:11], v[48:63]
    s_waitcnt lgkmcnt(4)
    v_mfma_f32_32x32x16_bf16 v[48:63], v[236:239], a[12:15], v[48:63]
    s_waitcnt lgkmcnt(3)
    v_mfma_f32_32x32x16_bf16 v[48:63], v[240:243], a[16:19], v[48:63]
    s_waitcnt lgkmcnt(2)
    v_mfma_f32_32x32x16_bf16 v[48:63], v[244:247], a[20:23], v[48:63]
    s_waitcnt lgkmcnt(1)
    v_mfma_f32_32x32x16_bf16 v[48:63], v[248:251], a[24:27], v[48:63]
    s_waitcnt lgkmcnt(0)
    v_mfma_f32_32x32x16_bf16 v[48:63], v[252:255], a[28:31], v[48:63]
    s_barrier
    s_nop 10
    v_cvt_pk_bf16_f32 v48, v48, v49
    v_cvt_pk_bf16_f32 v49, v50, v51
    v_cvt_pk_bf16_f32 v50, v52, v53
    v_cvt_pk_bf16_f32 v51, v54, v55
    buffer_store_dwordx4 v[48:51], v1, s[48:51], s61 offen offset:0 sc1
    v_cvt_pk_bf16_f32 v56, v56, v57
    v_cvt_pk_bf16_f32 v57, v58, v59
    v_cvt_pk_bf16_f32 v58, v60, v61
    v_cvt_pk_bf16_f32 v59, v62, v63
    buffer_store_dwordx4 v[56:59], v1, s[48:51], s61 offen offset:1024 sc1
    s_branch L_bE_40
L_bY_39:
    ds_read_b128 a[0:3], v4 offset:0
    ds_read_b128 a[4:7], v4 offset:1024
    ds_read_b128 a[8:11], v4 offset:3072
    ds_read_b128 a[12:15], v4 offset:4096
    ds_read_b128 a[16:19], v4 offset:6144
    ds_read_b128 a[20:23], v4 offset:7168
    s_waitcnt vmcnt(8)
    s_waitcnt lgkmcnt(5)
    v_mfma_f32_32x32x16_bf16 v[16:31], a[0:3], v[64:67], 0
    s_add_u32 s64, s64, 4096
    buffer_load_dwordx4 v[112:115], v1, s[48:51], s64 offen offset:0 sc1
    s_lshl_b32 s57, s54, 2
    s_add_u32 s57, s57, s3
    ds_read_b128 a[24:27], v4 offset:9216
    s_waitcnt lgkmcnt(5)
    v_mfma_f32_32x32x16_bf16 v[32:47], v[64:67], a[4:7], 0
    s_mul_i32 s56, s57, 48
    s_lshr_b32 s63, s55, 1
    ds_read_b128 a[28:31], v4 offset:10240
    s_waitcnt lgkmcnt(5)
    v_mfma_f32_32x32x16_bf16 v[16:31], a[8:11], v[68:71], v[16:31]
    buffer_load_dwordx4 v[116:119], v1, s[48:51], s64 offen offset:1024 sc1
    s_mul_i32 s58, s63, 6
    s_add_u32 s56, s56, s58
    ds_read_b128 a[0:3], v4 offset:12288
    s_waitcnt lgkmcnt(5)
    v_mfma_f32_32x32x16_bf16 v[32:47], v[68:71], a[12:15], v[32:47]
    s_lshl_b32 s56, s56, 10
    s_add_u32 s60, s56, 8392704
    ds_read_b128 a[4:7], v4 offset:13312
    s_waitcnt lgkmcnt(5)
    v_mfma_f32_32x32x16_bf16 v[16:31], a[16:19], v[72:75], v[16:31]
    buffer_load_dwordx4 v[120:123], v1, s[48:51], s64 offen offset:2048 sc1
    s_lshl_b32 s57, s57, 4
    s_add_u32 s57, s57, s55
    ds_read_b128 a[8:11], v4 offset:15360
    s_waitcnt lgkmcnt(5)
    v_mfma_f32_32x32x16_bf16 v[32:47], v[72:75], a[20:23], v[32:47]
    s_lshl_b32 s57, s57, 3
    s_add_u32 s89, s57, 19550208
    ds_read_b128 a[12:15], v4 offset:16384
    s_waitcnt lgkmcnt(5)
    v_mfma_f32_32x32x16_bf16 v[16:31], a[24:27], v[76:79], v[16:31]
    buffer_load_dwordx4 v[124:127], v1, s[48:51], s64 offen offset:3072 sc1
    s_lshr_b32 s58, s54, 3
    s_mul_i32 s56, s58, 24
    ds_read_b128 a[16:19], v4 offset:18432
    s_waitcnt lgkmcnt(5)
    v_mfma_f32_32x32x16_bf16 v[32:47], v[76:79], a[28:31], v[32:47]
    s_mul_i32 s57, s63, 3
    s_add_u32 s56, s56, s57
    ds_read_b128 a[20:23], v4 offset:19456
    s_waitcnt vmcnt(8)
    s_waitcnt lgkmcnt(5)
    v_mfma_f32_32x32x16_bf16 v[16:31], a[0:3], v[80:83], v[16:31]
    s_add_u32 s64, s64, 4096
    buffer_load_dwordx4 v[128:131], v1, s[48:51], s64 offen offset:0 sc1
    s_lshl_b32 s56, s56, 6
    s_and_b32 s57, s54, 7
    ds_read_b128 a[24:27], v4 offset:21504
    s_waitcnt lgkmcnt(5)
    v_mfma_f32_32x32x16_bf16 v[32:47], v[80:83], a[4:7], v[32:47]
    s_lshl_b32 s61, s57, 3
    s_add_u32 s56, s56, s61
    ds_read_b128 a[28:31], v4 offset:22528
    s_waitcnt lgkmcnt(5)
    v_mfma_f32_32x32x16_bf16 v[16:31], a[8:11], v[84:87], v[16:31]
    buffer_load_dwordx4 v[132:135], v1, s[48:51], s64 offen offset:1024 sc1
    s_lshl_b32 s61, s3, 1
    s_add_u32 s56, s56, s61
    ds_read_b128 a[0:3], v4 offset:24576
    s_waitcnt lgkmcnt(5)
    v_mfma_f32_32x32x16_bf16 v[32:47], v[84:87], a[12:15], v[32:47]
    s_lshl_b32 s56, s56, 10
    s_add_u32 s61, s56, 11599872
    ds_read_b128 a[4:7], v4 offset:25600
    s_waitcnt lgkmcnt(5)
    v_mfma_f32_32x32x16_bf16 v[16:31], a[16:19], v[88:91], v[16:31]
    buffer_load_dwordx4 v[136:139], v1, s[48:51], s64 offen offset:2048 sc1
    s_lshl_b32 s58, s58, 3
    s_add_u32 s58, s58, s63
    ds_read_b128 a[8:11], v4 offset:27648
    s_waitcnt lgkmcnt(5)
    v_mfma_f32_32x32x16_bf16 v[32:47], v[88:91], a[20:23], v[32:47]
    s_lshl_b32 s58, s58, 6
    s_lshl_b32 s57, s57, 2
    ds_read_b128 a[12:15], v4 offset:28672
    s_waitcnt lgkmcnt(5)
    v_mfma_f32_32x32x16_bf16 v[16:31], a[24:27], v[92:95], v[16:31]
    buffer_load_dwordx4 v[140:143], v1, s[48:51], s64 offen offset:3072 sc1
    s_add_u32 s58, s58, s57
    s_add_u32 s58, s58, s3
    ds_read_b128 a[16:19], v4 offset:30720
    s_waitcnt lgkmcnt(5)
    v_mfma_f32_32x32x16_bf16 v[32:47], v[92:95], a[28:31], v[32:47]
    s_lshl_b32 s58, s58, 3
    s_add_u32 s59, s58, 19558656
    ds_read_b128 a[20:23], v4 offset:31744
    s_waitcnt vmcnt(8)
    s_waitcnt lgkmcnt(5)
    v_mfma_f32_32x32x16_bf16 v[16:31], a[0:3], v[96:99], v[16:31]
    s_add_u32 s64, s64, 4096
    buffer_load_dwordx4 v[144:147], v1, s[48:51], s64 offen offset:0 sc1
    ds_read_b128 a[24:27], v4 offset:33792
    s_waitcnt lgkmcnt(5)
    v_mfma_f32_32x32x16_bf16 v[32:47], v[96:99], a[4:7], v[32:47]
    ds_read_b128 a[28:31], v4 offset:34816
    s_waitcnt lgkmcnt(5)
    v_mfma_f32_32x32x16_bf16 v[16:31], a[8:11], v[100:103], v[16:31]
    buffer_load_dwordx4 v[148:151], v1, s[48:51], s64 offen offset:1024 sc1
    ds_read_b128 a[0:3], v4 offset:36864
    s_waitcnt lgkmcnt(5)
    v_mfma_f32_32x32x16_bf16 v[32:47], v[100:103], a[12:15], v[32:47]
    ds_read_b128 a[4:7], v4 offset:37888
    s_waitcnt lgkmcnt(5)
    v_mfma_f32_32x32x16_bf16 v[16:31], a[16:19], v[104:107], v[16:31]
    buffer_load_dwordx4 v[152:155], v1, s[48:51], s64 offen offset:2048 sc1
    ds_read_b128 a[8:11], v4 offset:39936
    s_waitcnt lgkmcnt(5)
    v_mfma_f32_32x32x16_bf16 v[32:47], v[104:107], a[20:23], v[32:47]
    ds_read_b128 a[12:15], v4 offset:40960
    s_waitcnt lgkmcnt(5)
    v_mfma_f32_32x32x16_bf16 v[16:31], a[24:27], v[108:111], v[16:31]
    buffer_load_dwordx4 v[156:159], v1, s[48:51], s64 offen offset:3072 sc1
    ds_read_b128 a[16:19], v4 offset:43008
    s_waitcnt lgkmcnt(5)
    v_mfma_f32_32x32x16_bf16 v[32:47], v[108:111], a[28:31], v[32:47]
    ds_read_b128 a[20:23], v4 offset:44032
    s_waitcnt vmcnt(8)
    s_waitcnt lgkmcnt(5)
    v_mfma_f32_32x32x16_bf16 v[16:31], a[0:3], v[112:115], v[16:31]
    s_add_u32 s64, s64, 4096
    buffer_load_dwordx4 v[160:163], v1, s[48:51], s64 offen offset:0 sc1
    ds_read_b128 a[24:27], v4 offset:46080
    s_waitcnt lgkmcnt(5)
    v_mfma_f32_32x32x16_bf16 v[32:47], v[112:115], a[4:7], v[32:47]
    ds_read_b128 a[28:31], v4 offset:47104
    s_waitcnt lgkmcnt(5)
    v_mfma_f32_32x32x16_bf16 v[16:31], a[8:11], v[116:119], v[16:31]
    buffer_load_dwordx4 v[164:167], v1, s[48:51], s64 offen offset:1024 sc1
    ds_read_b128 a[0:3], v4 offset:49152
    s_waitcnt lgkmcnt(5)
    v_mfma_f32_32x32x16_bf16 v[32:47], v[116:119], a[12:15], v[32:47]
    ds_read_b128 a[4:7], v4 offset:50176
    s_waitcnt lgkmcnt(5)
    v_mfma_f32_32x32x16_bf16 v[16:31], a[16:19], v[120:123], v[16:31]
    buffer_load_dwordx4 v[168:171], v1, s[48:51], s64 offen offset:2048 sc1
    ds_read_b128 a[8:11], v4 offset:52224
    s_waitcnt lgkmcnt(5)
    v_mfma_f32_32x32x16_bf16 v[32:47], v[120:123], a[20:23], v[32:47]
    ds_read_b128 a[12:15], v4 offset:53248
    s_waitcnt lgkmcnt(5)
    v_mfma_f32_32x32x16_bf16 v[16:31], a[24:27], v[124:127], v[16:31]
    buffer_load_dwordx4 v[172:175], v1, s[48:51], s64 offen offset:3072 sc1
    ds_read_b128 a[16:19], v4 offset:55296
    s_waitcnt lgkmcnt(5)
    v_mfma_f32_32x32x16_bf16 v[32:47], v[124:127], a[28:31], v[32:47]
    ds_read_b128 a[20:23], v4 offset:56320
    s_waitcnt vmcnt(8)
    s_waitcnt lgkmcnt(5)
    v_mfma_f32_32x32x16_bf16 v[16:31], a[0:3], v[128:131], v[16:31]
    s_add_u32 s64, s64, 4096
    buffer_load_dwordx4 v[176:179], v1, s[48:51], s64 offen offset:0 sc1
    ds_read_b128 a[24:27], v4 offset:58368
    s_waitcnt lgkmcnt(5)
    v_mfma_f32_32x32x16_bf16 v[32:47], v[128:131], a[4:7], v[32:47]
    ds_read_b128 a[28:31], v4 offset:59392
    s_waitcnt lgkmcnt(5)
    v_mfma_f32_32x32x16_bf16 v[16:31], a[8:11], v[132:135], v[16:31]
    buffer_load_dwordx4 v[180:183], v1, s[48:51], s64 offen offset:1024 sc1
    ds_read_b128 a[0:3], v4 offset:61440
    s_waitcnt lgkmcnt(5)
    v_mfma_f32_32x32x16_bf16 v[32:47], v[132:135], a[12:15], v[32:47]
    ds_read_b128 a[4:7], v4 offset:62464
    s_waitcnt lgkmcnt(5)
    v_mfma_f32_32x32x16_bf16 v[16:31], a[16:19], v[136:139], v[16:31]
    buffer_load_dwordx4 v[184:187], v1, s[48:51], s64 offen offset:2048 sc1
    ds_read_b128 a[8:11], v4 offset:64512
    s_waitcnt lgkmcnt(5)
    v_mfma_f32_32x32x16_bf16 v[32:47], v[136:139], a[20:23], v[32:47]
    ds_read_b128 a[12:15], v5 offset:0
    s_waitcnt lgkmcnt(5)
    v_mfma_f32_32x32x16_bf16 v[16:31], a[24:27], v[140:143], v[16:31]
    buffer_load_dwordx4 v[188:191], v1, s[48:51], s64 offen offset:3072 sc1
    ds_read_b128 a[16:19], v5 offset:2048
    s_waitcnt lgkmcnt(5)
    v_mfma_f32_32x32x16_bf16 v[32:47], v[140:143], a[28:31], v[32:47]
    s_mov_b64 exec, s[12:13]
    buffer_load_dwordx2 v[12:13], v10, s[48:51], 0 offen sc1
    s_mov_b64 exec, -1
    ds_read_b128 a[20:23], v5 offset:3072
    s_waitcnt vmcnt(9)
    s_waitcnt lgkmcnt(5)
    v_mfma_f32_32x32x16_bf16 v[16:31], a[0:3], v[144:147], v[16:31]
    s_add_u32 s64, s64, 4096
    buffer_load_dwordx4 v[192:195], v1, s[48:51], s64 offen offset:0 sc1
    ds_read_b128 a[24:27], v5 offset:5120
    s_waitcnt lgkmcnt(5)
    v_mfma_f32_32x32x16_bf16 v[32:47], v[144:147], a[4:7], v[32:47]
    ds_read_b128 a[28:31], v5 offset:6144
    s_waitcnt lgkmcnt(5)
    v_mfma_f32_32x32x16_bf16 v[16:31], a[8:11], v[148:151], v[16:31]
    buffer_load_dwordx4 v[196:199], v1, s[48:51], s64 offen offset:1024 sc1
    ds_read_b128 a[0:3], v5 offset:8192
    s_waitcnt lgkmcnt(5)
    v_mfma_f32_32x32x16_bf16 v[32:47], v[148:151], a[12:15], v[32:47]
    ds_read_b128 a[4:7], v5 offset:9216
    s_waitcnt lgkmcnt(5)
    v_mfma_f32_32x32x16_bf16 v[16:31], a[16:19], v[152:155], v[16:31]
    buffer_load_dwordx4 v[200:203], v1, s[48:51], s64 offen offset:2048 sc1
    ds_read_b128 a[8:11], v5 offset:11264
    s_waitcnt lgkmcnt(5)
    v_mfma_f32_32x32x16_bf16 v[32:47], v[152:155], a[20:23], v[32:47]
    ds_read_b128 a[12:15], v5 offset:12288
    s_waitcnt lgkmcnt(5)
    v_mfma_f32_32x32x16_bf16 v[16:31], a[24:27], v[156:159], v[16:31]
    buffer_load_dwordx4 v[204:207], v1, s[48:51], s64 offen offset:3072 sc1
    ds_read_b128 a[16:19], v5 offset:14336
    s_waitcnt lgkmcnt(5)
    v_mfma_f32_32x32x16_bf16 v[32:47], v[156:159], a[28:31], v[32:47]
    ds_read_b128 a[20:23], v5 offset:15360
    s_waitcnt vmcnt(9)
    s_waitcnt lgkmcnt(5)
    v_mfma_f32_32x32x16_bf16 v[16:31], a[0:3], v[160:163], v[16:31]
    s_add_u32 s64, s64, 4096
    buffer_load_dwordx4 v[208:211], v1, s[48:51], s64 offen offset:0 sc1
    ds_read_b128 a[24:27], v5 offset:17408
    s_waitcnt lgkmcnt(5)
    v_mfma_f32_32x32x16_bf16 v[32:47], v[160:163], a[4:7], v[32:47]
    ds_read_b128 a[28:31], v5 offset:18432
    s_waitcnt lgkmcnt(5)
    v_mfma_f32_32x32x16_bf16 v[16:31], a[8:11], v[164:167], v[16:31]
    buffer_load_dwordx4 v[212:215], v1, s[48:51], s64 offen offset:1024 sc1
    ds_read_b128 a[0:3], v5 offset:20480
    s_waitcnt lgkmcnt(5)
    v_mfma_f32_32x32x16_bf16 v[32:47], v[164:167], a[12:15], v[32:47]
    ds_read_b128 a[4:7], v5 offset:21504
    s_waitcnt lgkmcnt(5)
    v_mfma_f32_32x32x16_bf16 v[16:31], a[16:19], v[168:171], v[16:31]
    buffer_load_dwordx4 v[216:219], v1, s[48:51], s64 offen offset:2048 sc1
    ds_read_b128 a[8:11], v5 offset:23552
    s_waitcnt lgkmcnt(5)
    v_mfma_f32_32x32x16_bf16 v[32:47], v[168:171], a[20:23], v[32:47]
    ds_read_b128 a[12:15], v5 offset:24576
    s_waitcnt lgkmcnt(5)
    v_mfma_f32_32x32x16_bf16 v[16:31], a[24:27], v[172:175], v[16:31]
    buffer_load_dwordx4 v[220:223], v1, s[48:51], s64 offen offset:3072 sc1
    ds_read_b128 a[16:19], v5 offset:26624
    s_waitcnt lgkmcnt(5)
    v_mfma_f32_32x32x16_bf16 v[32:47], v[172:175], a[28:31], v[32:47]
    ds_read_b128 a[20:23], v5 offset:27648
    s_waitcnt vmcnt(9)
    s_waitcnt lgkmcnt(5)
    v_mfma_f32_32x32x16_bf16 v[16:31], a[0:3], v[176:179], v[16:31]
    s_add_u32 s64, s64, 4096
    buffer_load_dwordx4 v[224:227], v1, s[48:51], s64 offen offset:0 sc1
    ds_read_b128 a[24:27], v5 offset:29696
    s_waitcnt lgkmcnt(5)
    v_mfma_f32_32x32x16_bf16 v[32:47], v[176:179], a[4:7], v[32:47]
    ds_read_b128 a[28:31], v5 offset:30720
    s_waitcnt lgkmcnt(5)
    v_mfma_f32_32x32x16_bf16 v[16:31], a[8:11], v[180:183], v[16:31]
    buffer_load_dwordx4 v[228:231], v1, s[48:51], s64 offen offset:1024 sc1
    ds_read_b128 a[0:3], v5 offset:32768
    s_waitcnt lgkmcnt(5)
    v_mfma_f32_32x32x16_bf16 v[32:47], v[180:183], a[12:15], v[32:47]
    ds_read_b128 a[4:7], v5 offset:33792
    s_waitcnt lgkmcnt(5)
    v_mfma_f32_32x32x16_bf16 v[16:31], a[16:19], v[184:187], v[16:31]
    buffer_load_dwordx4 v[232:235], v1, s[48:51], s64 offen offset:2048 sc1
    ds_read_b128 a[8:11], v5 offset:35840
    s_waitcnt lgkmcnt(5)
    v_mfma_f32_32x32x16_bf16 v[32:47], v[184:187], a[20:23], v[32:47]
    ds_read_b128 a[12:15], v5 offset:36864
    s_waitcnt lgkmcnt(5)
    v_mfma_f32_32x32x16_bf16 v[16:31], a[24:27], v[188:191], v[16:31]
    buffer_load_dwordx4 v[236:239], v1, s[48:51], s64 offen offset:3072 sc1
    ds_read_b128 a[16:19], v5 offset:38912
    s_waitcnt lgkmcnt(5)
    v_mfma_f32_32x32x16_bf16 v[32:47], v[188:191], a[28:31], v[32:47]
    ds_read_b128 a[20:23], v5 offset:39936
    s_waitcnt vmcnt(8)
    s_waitcnt lgkmcnt(5)
    v_mfma_f32_32x32x16_bf16 v[16:31], a[0:3], v[192:195], v[16:31]
    s_add_u32 s64, s64, 4096
    buffer_load_dwordx4 v[240:243], v1, s[48:51], s64 offen offset:0 sc1
    ds_read_b128 a[24:27], v5 offset:41984
    s_waitcnt lgkmcnt(5)
    v_mfma_f32_32x32x16_bf16 v[32:47], v[192:195], a[4:7], v[32:47]
    ds_read_b128 a[28:31], v5 offset:43008
    s_waitcnt lgkmcnt(5)
    v_mfma_f32_32x32x16_bf16 v[16:31], a[8:11], v[196:199], v[16:31]
    buffer_load_dwordx4 v[244:247], v1, s[48:51], s64 offen offset:1024 sc1
    ds_read_b128 a[0:3], v5 offset:45056
    s_waitcnt lgkmcnt(5)
    v_mfma_f32_32x32x16_bf16 v[32:47], v[196:199], a[12:15], v[32:47]
    ds_read_b128 a[4:7], v5 offset:46080
    s_waitcnt lgkmcnt(5)
    v_mfma_f32_32x32x16_bf16 v[16:31], a[16:19], v[200:203], v[16:31]
    buffer_load_dwordx4 v[248:251], v1, s[48:51], s64 offen offset:2048 sc1
    ds_read_b128 a[8:11], v5 offset:48128
    s_waitcnt lgkmcnt(5)
    v_mfma_f32_32x32x16_bf16 v[32:47], v[200:203], a[20:23], v[32:47]
    ds_read_b128 a[12:15], v5 offset:49152
    s_waitcnt lgkmcnt(5)
    v_mfma_f32_32x32x16_bf16 v[16:31], a[24:27], v[204:207], v[16:31]
    buffer_load_dwordx4 v[252:255], v1, s[48:51], s64 offen offset:3072 sc1
    ds_read_b128 a[16:19], v5 offset:51200
    s_waitcnt lgkmcnt(5)
    v_mfma_f32_32x32x16_bf16 v[32:47], v[204:207], a[28:31], v[32:47]
    s_mov_b64 exec, s[12:13]
    v_cmp_ne_u64 vcc, v[12:13], v[2:3]
    s_cbranch_vccz L_w2ok_44
    s_mov_b32 s88, 0
    s_mov_b64 exec, s[12:13]
L_spin_45:
    buffer_load_dwordx2 v[12:13], v10, s[48:51], 0 offen sc1
    s_waitcnt vmcnt(0)
    v_cmp_ne_u64 vcc, v[12:13], v[2:3]
    s_cbranch_vccz L_spun_46
    s_add_u32 s88, s88, 1
    s_cmp_lt_u32 s88, 262144
    s_cbranch_scc1 L_spin_45
L_spun_46:
    s_mov_b64 exec, -1
L_w2ok_44:
    s_mov_b64 exec, -1
    ds_read_b128 a[20:23], v5 offset:52224
    s_waitcnt vmcnt(8)
    s_waitcnt lgkmcnt(5)
    v_mfma_f32_32x32x16_bf16 v[16:31], a[0:3], v[208:211], v[16:31]
    s_add_u32 s67, s69, 0
    s_add_u32 m0, s66, 0
    s_nop 0
    buffer_load_dwordx4 v1, s[48:51], s67 offen offset:2048 sc1 lds
    ds_read_b128 a[24:27], v5 offset:54272
    s_waitcnt lgkmcnt(5)
    v_mfma_f32_32x32x16_bf16 v[32:47], v[208:211], a[4:7], v[32:47]
    ds_read_b128 a[28:31], v5 offset:55296
    s_waitcnt lgkmcnt(5)
    v_mfma_f32_32x32x16_bf16 v[16:31], a[8:11], v[212:215], v[16:31]
    s_add_u32 s67, s69, 12288
    s_add_u32 m0, s66, 12288
    s_nop 0
    buffer_load_dwordx4 v1, s[48:51], s67 offen offset:2048 sc1 lds
    ds_read_b128 a[0:3], v5 offset:57344
    s_waitcnt lgkmcnt(5)
    v_mfma_f32_32x32x16_bf16 v[32:47], v[212:215], a[12:15], v[32:47]
    ds_read_b128 a[4:7], v5 offset:58368
    s_waitcnt lgkmcnt(5)
    v_mfma_f32_32x32x16_bf16 v[16:31], a[16:19], v[216:219], v[16:31]
    s_add_u32 s67, s69, 24576
    s_add_u32 m0, s66, 24576
    s_nop 0
    buffer_load_dwordx4 v1, s[48:51], s67 offen offset:2048 sc1 lds
    ds_read_b128 a[8:11], v5 offset:60416
    s_waitcnt lgkmcnt(5)
    v_mfma_f32_32x32x16_bf16 v[32:47], v[216:219], a[20:23], v[32:47]
    ds_read_b128 a[12:15], v5 offset:61440
    s_waitcnt lgkmcnt(5)
    v_mfma_f32_32x32x16_bf16 v[16:31], a[24:27], v[220:223], v[16:31]
    s_add_u32 s67, s69, 36864
    s_add_u32 m0, s66, 36864
    s_nop 0
    buffer_load_dwordx4 v1, s[48:51], s67 offen offset:2048 sc1 lds
    ds_read_b128 a[16:19], v5 offset:63488
    s_waitcnt lgkmcnt(5)
    v_mfma_f32_32x32x16_bf16 v[32:47], v[220:223], a[28:31], v[32:47]
    ds_read_b128 a[20:23], v5 offset:64512
    s_waitcnt vmcnt(8)
    s_waitcnt lgkmcnt(5)
    v_mfma_f32_32x32x16_bf16 v[16:31], a[0:3], v[224:227], v[16:31]
    s_add_u32 s67, s69, 49152
    s_add_u32 m0, s66, 49152
    s_nop 0
    buffer_load_dwordx4 v1, s[48:51], s67 offen offset:2048 sc1 lds
    ds_read_b128 a[24:27], v6 offset:1024
    s_waitcnt lgkmcnt(5)
    v_mfma_f32_32x32x16_bf16 v[32:47], v[224:227], a[4:7], v[32:47]
    ds_read_b128 a[28:31], v6 offset:2048
    s_waitcnt lgkmcnt(5)
    v_mfma_f32_32x32x16_bf16 v[16:31], a[8:11], v[228:231], v[16:31]
    s_add_u32 s67, s69, 61440
    s_add_u32 m0, s66, 61440
    s_nop 0
    buffer_load_dwordx4 v1, s[48:51], s67 offen offset:2048 sc1 lds
    ds_read_b128 a[0:3], v6 offset:4096
    s_waitcnt lgkmcnt(5)
    v_mfma_f32_32x32x16_bf16 v[32:47], v[228:231], a[12:15], v[32:47]
    ds_read_b128 a[4:7], v6 offset:5120
    s_waitcnt lgkmcnt(5)
    v_mfma_f32_32x32x16_bf16 v[16:31], a[16:19], v[232:235], v[16:31]
    s_add_u32 s67, s69, 73728
    s_add_u32 m0, s66, 73728
    s_nop 0
    buffer_load_dwordx4 v1, s[48:51], s67 offen offset:2048 sc1 lds
    ds_read_b128 a[8:11], v6 offset:7168
    s_waitcnt lgkmcnt(5)
    v_mfma_f32_32x32x16_bf16 v[32:47], v[232:235], a[20:23], v[32:47]
    ds_read_b128 a[12:15], v6 offset:8192
    s_waitcnt lgkmcnt(5)
    v_mfma_f32_32x32x16_bf16 v[16:31], a[24:27], v[236:239], v[16:31]
    s_add_u32 s67, s69, 86016
    s_add_u32 m0, s66, 86016
    s_nop 0
    buffer_load_dwordx4 v1, s[48:51], s67 offen offset:2048 sc1 lds
    ds_read_b128 a[16:19], v6 offset:10240
    s_waitcnt lgkmcnt(5)
    v_mfma_f32_32x32x16_bf16 v[32:47], v[236:239], a[28:31], v[32:47]
    ds_read_b128 a[20:23], v6 offset:11264
    s_waitcnt vmcnt(8)
    s_waitcnt lgkmcnt(5)
    v_mfma_f32_32x32x16_bf16 v[16:31], a[0:3], v[240:243], v[16:31]
    s_add_u32 s67, s69, 98304
    s_add_u32 m0, s66, 98304
    s_nop 0
    buffer_load_dwordx4 v1, s[48:51], s67 offen offset:2048 sc1 lds
    ds_read_b128 a[24:27], v6 offset:13312
    s_waitcnt lgkmcnt(5)
    v_mfma_f32_32x32x16_bf16 v[32:47], v[240:243], a[4:7], v[32:47]
    ds_read_b128 a[28:31], v6 offset:14336
    s_waitcnt lgkmcnt(5)
    v_mfma_f32_32x32x16_bf16 v[16:31], a[8:11], v[244:247], v[16:31]
    s_add_u32 s67, s69, 110592
    s_add_u32 m0, s66, 110592
    s_nop 0
    buffer_load_dwordx4 v1, s[48:51], s67 offen offset:2048 sc1 lds
    s_waitcnt lgkmcnt(4)
    v_mfma_f32_32x32x16_bf16 v[32:47], v[244:247], a[12:15], v[32:47]
    s_waitcnt lgkmcnt(3)
    v_mfma_f32_32x32x16_bf16 v[16:31], a[16:19], v[248:251], v[16:31]
    s_add_u32 s67, s69, 122880
    s_add_u32 m0, s66, 122880
    s_nop 0
    buffer_load_dwordx4 v1, s[48:51], s67 offen offset:2048 sc1 lds
    s_waitcnt lgkmcnt(2)
    v_mfma_f32_32x32x16_bf16 v[32:47], v[248:251], a[20:23], v[32:47]
    s_waitcnt lgkmcnt(1)
    v_mfma_f32_32x32x16_bf16 v[16:31], a[24:27], v[252:255], v[16:31]
    s_add_u32 s67, s69, 135168
    s_add_u32 m0, s66, 135168
    s_nop 0
    buffer_load_dwordx4 v1, s[48:51], s67 offen offset:2048 sc1 lds
    s_waitcnt lgkmcnt(0)
    v_mfma_f32_32x32x16_bf16 v[32:47], v[252:255], a[28:31], v[32:47]
    s_nop 5
    v_cvt_pk_bf16_f32 v16, v16, v17
    v_cvt_pk_bf16_f32 v17, v18, v19
    v_cvt_pk_bf16_f32 v18, v20, v21
    v_cvt_pk_bf16_f32 v19, v22, v23
    buffer_store_dwordx4 v[16:19], v1, s[48:51], s60 offen offset:0 sc1
    v_cvt_pk_bf16_f32 v24, v24, v25
    v_cvt_pk_bf16_f32 v25, v26, v27
    v_cvt_pk_bf16_f32 v26, v28, v29
    v_cvt_pk_bf16_f32 v27, v30, v31
    buffer_store_dwordx4 v[24:27], v1, s[48:51], s60 offen offset:1024 sc1
    s_waitcnt vmcnt(6)
    s_barrier
    ds_read_b128 a[0:3], v4 offset:2048
    ds_read_b128 a[4:7], v4 offset:5120
    ds_read_b128 a[8:11], v4 offset:8192
    ds_read_b128 a[12:15], v4 offset:11264
    ds_read_b128 a[16:19], v4 offset:14336
    ds_read_b128 a[20:23], v4 offset:17408
    s_waitcnt lgkmcnt(5)
    v_mfma_f32_32x32x16_bf16 v[48:63], v[64:67], a[0:3], 0
    s_lshr_b32 s56, s52, 2
    s_lshl_b32 s56, s56, 4
    ds_read_b128 a[24:27], v4 offset:20480
    s_waitcnt lgkmcnt(5)
    v_mfma_f32_32x32x16_bf16 v[48:63], v[68:71], a[4:7], v[48:63]
    s_and_b32 s57, s52, 1
    s_xor_b32 s57, s57, 1
    ds_read_b128 a[28:31], v4 offset:23552
    s_waitcnt lgkmcnt(5)
    v_mfma_f32_32x32x16_bf16 v[48:63], v[72:75], a[8:11], v[48:63]
    s_lshl_b32 s57, s57, 3
    s_add_u32 s56, s56, s57
    ds_read_b128 a[0:3], v4 offset:26624
    s_waitcnt lgkmcnt(5)
    v_mfma_f32_32x32x16_bf16 v[48:63], v[76:79], a[12:15], v[48:63]
    s_and_b32 s57, s53, 7
    s_add_u32 s56, s56, s57
    ds_read_b128 a[4:7], v4 offset:29696
    s_waitcnt lgkmcnt(5)
    v_mfma_f32_32x32x16_bf16 v[48:63], v[80:83], a[16:19], v[48:63]
    s_mul_i32 s56, s56, 98304
    s_lshr_b32 s57, s52, 1
    ds_read_b128 a[8:11], v4 offset:32768
    s_waitcnt lgkmcnt(5)
    v_mfma_f32_32x32x16_bf16 v[48:63], v[84:87], a[20:23], v[48:63]
    s_and_b32 s57, s57, 1
    s_lshl_b32 s57, s57, 2
    ds_read_b128 a[12:15], v4 offset:35840
    s_waitcnt lgkmcnt(5)
    v_mfma_f32_32x32x16_bf16 v[48:63], v[88:91], a[24:27], v[48:63]
    s_lshr_b32 s58, s53, 3
    s_add_u32 s57, s57, s58
    ds_read_b128 a[16:19], v4 offset:38912
    s_waitcnt lgkmcnt(5)
    v_mfma_f32_32x32x16_bf16 v[48:63], v[92:95], a[28:31], v[48:63]
    s_mul_i32 s57, s57, 192
    s_add_u32 s56, s56, s57
    ds_read_b128 a[20:23], v4 offset:41984
    s_waitcnt lgkmcnt(5)
    v_mfma_f32_32x32x16_bf16 v[48:63], v[96:99], a[0:3], v[48:63]
    v_lshrrev_b32 v14, 3, v0
    s_lshl_b32 s57, s3, 3
    ds_read_b128 a[24:27], v4 offset:45056
    s_waitcnt lgkmcnt(5)
    v_mfma_f32_32x32x16_bf16 v[48:63], v[100:103], a[4:7], v[48:63]
    v_add_u32 v14, s57, v14
    v_mul_u32_u24 v14, 1536, v14
    ds_read_b128 a[28:31], v4 offset:48128
    s_waitcnt lgkmcnt(5)
    v_mfma_f32_32x32x16_bf16 v[48:63], v[104:107], a[8:11], v[48:63]
    v_and_b32 v15, 7, v0
    v_lshl_add_u32 v14, v15, 3, v14
    ds_read_b128 a[0:3], v4 offset:51200
    s_waitcnt lgkmcnt(5)
    v_mfma_f32_32x32x16_bf16 v[48:63], v[108:111], a[12:15], v[48:63]
    buffer_load_dwordx2 a[220:221], v14, s[20:23], s56 offen offset:0
    buffer_load_dwordx2 a[222:223], v14, s[20:23], s56 offen offset:64
    ds_read_b128 a[4:7], v4 offset:54272
    s_waitcnt lgkmcnt(5)
    v_mfma_f32_32x32x16_bf16 v[48:63], v[112:115], a[16:19], v[48:63]
    buffer_load_dwordx2 a[224:225], v14, s[20:23], s56 offen offset:128
    s_add_u32 s56, s56, 49152
    ds_read_b128 a[8:11], v4 offset:57344
    s_waitcnt lgkmcnt(5)
    v_mfma_f32_32x32x16_bf16 v[48:63], v[116:119], a[20:23], v[48:63]
    buffer_load_dwordx2 a[226:227], v14, s[20:23], s56 offen offset:0
    buffer_load_dwordx2 a[228:229], v14, s[20:23], s56 offen offset:64
    ds_read_b128 a[12:15], v4 offset:60416
    s_waitcnt lgkmcnt(5)
    v_mfma_f32_32x32x16_bf16 v[48:63], v[120:123], a[24:27], v[48:63]
    buffer_load_dwordx2 a[230:231], v14, s[20:23], s56 offen offset:128
    ds_read_b128 a[16:19], v4 offset:63488
    s_waitcnt lgkmcnt(5)
    v_mfma_f32_32x32x16_bf16 v[48:63], v[124:127], a[28:31], v[48:63]
    ds_read_b128 a[20:23], v5 offset:1024
    s_waitcnt lgkmcnt(5)
    v_mfma_f32_32x32x16_bf16 v[48:63], v[128:131], a[0:3], v[48:63]
    ds_read_b128 a[24:27], v5 offset:4096
    s_waitcnt lgkmcnt(5)
    v_mfma_f32_32x32x16_bf16 v[48:63], v[132:135], a[4:7], v[48:63]
    ds_read_b128 a[28:31], v5 offset:7168
    s_waitcnt lgkmcnt(5)
    v_mfma_f32_32x32x16_bf16 v[48:63], v[136:139], a[8:11], v[48:63]
    ds_read_b128 a[0:3], v5 offset:10240
    s_waitcnt lgkmcnt(5)
    v_mfma_f32_32x32x16_bf16 v[48:63], v[140:143], a[12:15], v[48:63]
    ds_read_b128 a[4:7], v5 offset:13312
    s_waitcnt lgkmcnt(5)
    v_mfma_f32_32x32x16_bf16 v[48:63], v[144:147], a[16:19], v[48:63]
    s_waitcnt vmcnt(6)
    s_mov_b64 exec, 1
    buffer_store_dwordx2 v[2:3], off, s[48:51], s89 sc1
    s_mov_b64 exec, -1
    s_mov_b32 s89, s59
    ds_read_b128 a[8:11], v5 offset:16384
    s_waitcnt lgkmcnt(5)
    v_mfma_f32_32x32x16_bf16 v[48:63], v[148:151], a[20:23], v[48:63]
    v_cvt_pk_bf16_f32 v32, v32, v33
    v_cvt_pk_bf16_f32 v33, v34, v35
    ds_read_b128 a[12:15], v5 offset:19456
    s_waitcnt lgkmcnt(5)
    v_mfma_f32_32x32x16_bf16 v[48:63], v[152:155], a[24:27], v[48:63]
    v_cvt_pk_bf16_f32 v34, v36, v37
    v_cvt_pk_bf16_f32 v35, v38, v39
    ds_read_b128 a[16:19], v5 offset:22528
    s_waitcnt lgkmcnt(5)
    v_mfma_f32_32x32x16_bf16 v[48:63], v[156:159], a[28:31], v[48:63]
    buffer_store_dwordx4 v[32:35], v1, s[48:51], s61 offen offset:0 sc1
    v_cvt_pk_bf16_f32 v40, v40, v41
    ds_read_b128 a[20:23], v5 offset:25600
    s_waitcnt lgkmcnt(5)
    v_mfma_f32_32x32x16_bf16 v[48:63], v[160:163], a[0:3], v[48:63]
    v_cvt_pk_bf16_f32 v41, v42, v43
    v_cvt_pk_bf16_f32 v42, v44, v45
    ds_read_b128 a[24:27], v5 offset:28672
    s_waitcnt lgkmcnt(5)
    v_mfma_f32_32x32x16_bf16 v[48:63], v[164:167], a[4:7], v[48:63]
    v_cvt_pk_bf16_f32 v43, v46, v47
    buffer_store_dwordx4 v[40:43], v1, s[48:51], s61 offen offset:1024 sc1
    ds_read_b128 a[28:31], v5 offset:31744
    s_waitcnt lgkmcnt(5)
    v_mfma_f32_32x32x16_bf16 v[48:63], v[168:171], a[8:11], v[48:63]
    s_barrier
    ds_read_b128 a[0:3], v5 offset:34816
    s_waitcnt lgkmcnt(5)
    v_mfma_f32_32x32x16_bf16 v[48:63], v[172:175], a[12:15], v[48:63]
    ds_read_b128 a[4:7], v5 offset:37888
    s_waitcnt lgkmcnt(5)
    v_mfma_f32_32x32x16_bf16 v[48:63], v[176:179], a[16:19], v[48:63]
    ds_read_b128 a[8:11], v5 offset:40960
    s_waitcnt lgkmcnt(5)
    v_mfma_f32_32x32x16_bf16 v[48:63], v[180:183], a[20:23], v[48:63]
    ds_read_b128 a[12:15], v5 offset:44032
    s_waitcnt lgkmcnt(5)
    v_mfma_f32_32x32x16_bf16 v[48:63], v[184:187], a[24:27], v[48:63]
    ds_read_b128 a[16:19], v5 offset:47104
    s_waitcnt lgkmcnt(5)
    v_mfma_f32_32x32x16_bf16 v[48:63], v[188:191], a[28:31], v[48:63]
    ds_read_b128 a[20:23], v5 offset:50176
    s_waitcnt lgkmcnt(5)
    v_mfma_f32_32x32x16_bf16 v[48:63], v[192:195], a[0:3], v[48:63]
    ds_read_b128 a[24:27], v5 offset:53248
    s_waitcnt lgkmcnt(5)
    v_mfma_f32_32x32x16_bf16 v[48:63], v[196:199], a[4:7], v[48:63]
    ds_read_b128 a[28:31], v5 offset:56320
    s_waitcnt lgkmcnt(5)
    v_mfma_f32_32x32x16_bf16 v[48:63], v[200:203], a[8:11], v[48:63]
    ds_read_b128 a[0:3], v5 offset:59392
    s_waitcnt lgkmcnt(5)
    v_mfma_f32_32x32x16_bf16 v[48:63], v[204:207], a[12:15], v[48:63]
    ds_read_b128 a[4:7], v5 offset:62464
    s_waitcnt lgkmcnt(5)
    v_mfma_f32_32x32x16_bf16 v[48:63], v[208:211], a[16:19], v[48:63]
    ds_read_b128 a[8:11], v6 offset:0
    s_waitcnt lgkmcnt(5)
    v_mfma_f32_32x32x16_bf16 v[48:63], v[212:215], a[20:23], v[48:63]
    ds_read_b128 a[12:15], v6 offset:3072
    s_waitcnt lgkmcnt(5)
    v_mfma_f32_32x32x16_bf16 v[48:63], v[216:219], a[24:27], v[48:63]
    ds_read_b128 a[16:19], v6 offset:6144
    s_waitcnt lgkmcnt(5)
    v_mfma_f32_32x32x16_bf16 v[48:63], v[220:223], a[28:31], v[48:63]
    ds_read_b128 a[20:23], v6 offset:9216
    s_waitcnt lgkmcnt(5)
    v_mfma_f32_32x32x16_bf16 v[48:63], v[224:227], a[0:3], v[48:63]
    ds_read_b128 a[24:27], v6 offset:12288
    s_waitcnt lgkmcnt(5)
    v_mfma_f32_32x32x16_bf16 v[48:63], v[228:231], a[4:7], v[48:63]
    ds_read_b128 a[28:31], v6 offset:15360
    s_waitcnt lgkmcnt(5)
    v_mfma_f32_32x32x16_bf16 v[48:63], v[232:235], a[8:11], v[48:63]
    s_waitcnt lgkmcnt(4)
    v_mfma_f32_32x32x16_bf16 v[48:63], v[236:239], a[12:15], v[48:63]
    s_waitcnt lgkmcnt(3)
    v_mfma_f32_32x32x16_bf16 v[48:63], v[240:243], a[16:19], v[48:63]
    s_waitcnt lgkmcnt(2)
    v_mfma_f32_32x32x16_bf16 v[48:63], v[244:247], a[20:23], v[48:63]
    s_waitcnt lgkmcnt(1)
    v_mfma_f32_32x32x16_bf16 v[48:63], v[248:251], a[24:27], v[48:63]
    s_waitcnt lgkmcnt(0)
    v_mfma_f32_32x32x16_bf16 v[48:63], v[252:255], a[28:31], v[48:63]
    s_barrier
    s_add_u32 s61, s61, 65536
    s_nop 9
    v_cvt_pk_bf16_f32 v48, v48, v49
    v_cvt_pk_bf16_f32 v49, v50, v51
    v_cvt_pk_bf16_f32 v50, v52, v53
    v_cvt_pk_bf16_f32 v51, v54, v55
    buffer_store_dwordx4 v[48:51], v1, s[48:51], s61 offen offset:0 sc1
    v_cvt_pk_bf16_f32 v56, v56, v57
    v_cvt_pk_bf16_f32 v57, v58, v59
    v_cvt_pk_bf16_f32 v58, v60, v61
    v_cvt_pk_bf16_f32 v59, v62, v63
    buffer_store_dwordx4 v[56:59], v1, s[48:51], s61 offen offset:1024 sc1
L_bE_40:
    s_lshr_b32 s64, s52, 2
    s_and_b32 s56, s52, 1
    s_xor_b32 s56, s56, 1
    s_lshl_b32 s56, s56, 3
    s_and_b32 s65, s53, 7
    s_add_u32 s65, s65, s56
    s_lshr_b32 s56, s52, 1
    s_and_b32 s56, s56, 1
    s_lshl_b32 s56, s56, 2
    s_lshr_b32 s66, s53, 3
    s_add_u32 s66, s66, s56
    s_lshl_b32 s63, s64, 5
    s_lshl_b32 s56, s55, 1
    s_add_u32 s63, s63, s56
    s_mul_i32 s60, s63, 49152
    s_lshl_b32 s61, s3, 12
    s_add_u32 s60, s60, 8388608
    s_add_u32 s56, s3, s92
    s_cmp_ge_u32 s56, 12
    s_cselect_b32 s57, 12, 0
    s_sub_u32 s56, s56, s57
    s_lshl_b32 s57, s56, 12
    s_add_u32 s8, s57, s60
    s_add_u32 s56, s56, 4
    s_cmp_ge_u32 s56, 12
    s_cselect_b32 s57, 12, 0
    s_sub_u32 s56, s56, s57
    s_lshl_b32 s57, s56, 12
    s_add_u32 s9, s57, s60
    s_add_u32 s56, s56, 4
    s_cmp_ge_u32 s56, 12
    s_cselect_b32 s57, 12, 0
    s_sub_u32 s56, s56, s57
    s_lshl_b32 s57, s56, 12
    s_add_u32 s10, s57, s60
    s_lshl_b32 s56, s63, 7
    s_add_u32 s56, s56, 19550208
    s_mul_i32 s58, s66, 3
    s_lshr_b32 s58, s58, 1
    s_lshl_b32 s58, s58, 5
    s_add_u32 s58, s58, 19537664
    v_mov_b32 v9, s58
    v_mov_b32 v11, s56
    v_cmp_gt_u32 vcc, 32, v0
    s_nop 1
    v_cndmask_b32 v9, v9, v11, vcc
    v_lshl_add_u32 v9, v0, 3, v9
    s_lshl_b32 s57, s64, 3
    s_add_u32 s57, s57, s66
    s_lshl_b32 s57, s57, 9
    s_add_u32 s93, s57, 19558400
    s_lshl_b32 s56, s63, 6
    s_and_b32 s57, s54, 7
    s_lshl_b32 s58, s57, 3
    s_add_u32 s56, s56, s58
    s_lshl_b32 s58, s3, 1
    s_add_u32 s56, s56, s58
    s_lshl_b32 s56, s56, 10
    s_add_u32 s68, s56, 14680064
    s_lshl_b32 s56, s63, 3
    s_add_u32 s56, s56, s57
    s_lshl_b32 s56, s56, 2
    s_add_u32 s56, s56, s3
    s_lshl_b32 s94, s56, 8
    s_add_u32 s94, s94, 18874368
    s_lshl_b32 s95, s56, 3
    s_add_u32 s95, s95, 19566592
    s_mul_i32 s56, s64, 24
    s_mul_i32 s57, s66, 3
    s_add_u32 s56, s56, s57
    s_lshl_b32 s56, s56, 6
    s_lshl_b32 s57, s3, 4
    s_add_u32 s56, s56, s57
    s_lshl_b32 s56, s56, 10
    s_add_u32 s67, s56, 11534336
    s_lshl_b32 s56, s64, 4
    s_add_u32 s56, s56, s65
    s_mul_i32 s56, s56, 98304
    s_mul_i32 s57, s66, 192
    s_add_u32 s69, s56, s57
    v_lshrrev_b32 v14, 3, v0
    s_lshl_b32 s56, s3, 3
    v_add_u32 v14, s56, v14
    v_mul_u32_u24 v10, 1536, v14
    v_and_b32 v15, 7, v0
    v_lshl_add_u32 v10, v15, 3, v10
    v_lshlrev_b32 v15, 4, v15
    v_lshrrev_b32 v11, 3, v0
    v_and_b32 v11, 3, v11
    v_mul_u32_u24 v11, 6144, v11
    v_add_u32 v11, v11, v15
    v_lshrrev_b32 v15, 5, v0
    v_lshl_add_u32 v15, v15, 7, v11
    v_mov_b32 v4, v1
    v_add_u32 v5, 0x10000, v1
    v_and_b32 v8, 31, v0
    v_lshlrev_b32 v7, 4, v8
    v_add_u32 v7, 98304, v7
    s_lshl_b32 s56, s3, 2
    v_add_u32 v6, s56, v7
    v_lshlrev_b32 v8, 3, v8
    s_cmp_eq_u32 s3, 0
    s_cbranch_scc0 L_eo_47
    s_bfm_b64 exec, 40, 0
    buffer_load_dwordx2 v[12:13], v9, s[48:51], 0 offen sc1
    s_mov_b64 exec, -1
    s_waitcnt vmcnt(1)
    s_branch L_ej_48
L_eo_47:
    s_waitcnt vmcnt(0)
L_ej_48:
    s_mov_b64 exec, 1
    buffer_store_dwordx2 v[2:3], off, s[48:51], s89 sc1
    s_mov_b64 exec, -1
    s_cmp_eq_u32 s3, 0
    s_cbranch_scc0 L_tsp_49
    s_waitcnt vmcnt(1)
    s_bfm_b64 exec, 40, 0
    v_cmp_ne_u64 vcc, v[12:13], v[2:3]
    s_cbranch_vccz L_tok_50
    s_mov_b32 s88, 0
    s_bfm_b64 exec, 40, 0
L_spin_51:
    buffer_load_dwordx2 v[12:13], v9, s[48:51], 0 offen sc1
    s_waitcnt vmcnt(0)
    v_cmp_ne_u64 vcc, v[12:13], v[2:3]
    s_cbranch_vccz L_spun_52
    s_add_u32 s88, s88, 1
    s_cmp_lt_u32 s88, 262144
    s_cbranch_scc1 L_spin_51
L_spun_52:
    s_mov_b64 exec, -1
L_tok_50:
    s_mov_b64 exec, -1
L_tsp_49:
    s_barrier
    v_lshl_add_u32 v9, v0, 3, s93
    s_add_u32 s62, s8, 0
    s_add_u32 m0, s61, 0
    s_nop 0
    buffer_load_dwordx4 v1, s[48:51], s62 offen offset:0 sc1 lds
    buffer_load_dwordx4 v1, s[48:51], s62 offen offset:1024 sc1 lds
    buffer_load_dwordx4 v1, s[48:51], s62 offen offset:2048 sc1 lds
    buffer_load_dwordx4 v1, s[48:51], s62 offen offset:3072 sc1 lds
    s_add_u32 s62, s9, 0
    s_add_u32 m0, s61, 16384
    s_nop 0
    buffer_load_dwordx4 v1, s[48:51], s62 offen offset:0 sc1 lds
    buffer_load_dwordx4 v1, s[48:51], s62 offen offset:1024 sc1 lds
    buffer_load_dwordx4 v1, s[48:51], s62 offen offset:2048 sc1 lds
    buffer_load_dwordx4 v1, s[48:51], s62 offen offset:3072 sc1 lds
    s_add_u32 s62, s10, 0
    s_add_u32 m0, s61, 32768
    s_nop 0
    buffer_load_dwordx4 v1, s[48:51], s62 offen offset:0 sc1 lds
    buffer_load_dwordx4 v1, s[48:51], s62 offen offset:1024 sc1 lds
    buffer_load_dwordx4 v1, s[48:51], s62 offen offset:2048 sc1 lds
    buffer_load_dwordx4 v1, s[48:51], s62 offen offset:3072 sc1 lds
    s_waitcnt vmcnt(8)
    s_barrier
    ds_read_b128 a[192:195], v4 offset:0
    ds_read_b128 a[196:199], v4 offset:1024
    ds_read_b128 a[200:203], v4 offset:2048
    ds_read_b128 a[204:207], v4 offset:3072
    ds_read_b128 a[208:211], v4 offset:4096
    ds_read_b128 a[212:215], v4 offset:5120
    s_waitcnt lgkmcnt(5)
    v_mfma_f32_32x32x16_bf16 v[16:31], v[64:67], a[192:195], 0
    s_add_u32 s62, s8, 49152
    s_add_u32 m0, s61, 49152
    s_nop 0
    buffer_load_dwordx4 v1, s[48:51], s62 offen offset:0 sc1 lds
    ds_read_b128 a[216:219], v4 offset:6144
    s_waitcnt lgkmcnt(5)
    v_mfma_f32_32x32x16_bf16 v[16:31], v[68:71], a[196:199], v[16:31]
    ds_read_b128 a[192:195], v4 offset:7168
    s_waitcnt lgkmcnt(5)
    v_mfma_f32_32x32x16_bf16 v[16:31], v[72:75], a[200:203], v[16:31]
    ds_read_b128 a[196:199], v4 offset:8192
    s_waitcnt lgkmcnt(5)
    v_mfma_f32_32x32x16_bf16 v[16:31], v[76:79], a[204:207], v[16:31]
    buffer_load_dwordx4 v1, s[48:51], s62 offen offset:1024 sc1 lds
    ds_read_b128 a[200:203], v4 offset:9216
    s_waitcnt lgkmcnt(5)
    v_mfma_f32_32x32x16_bf16 v[16:31], v[80:83], a[208:211], v[16:31]
    ds_read_b128 a[204:207], v4 offset:10240
    s_waitcnt lgkmcnt(5)
    v_mfma_f32_32x32x16_bf16 v[16:31], v[84:87], a[212:215], v[16:31]
    ds_read_b128 a[208:211], v4 offset:11264
    s_waitcnt lgkmcnt(5)
    v_mfma_f32_32x32x16_bf16 v[16:31], v[88:91], a[216:219], v[16:31]
    buffer_load_dwordx4 v1, s[48:51], s62 offen offset:2048 sc1 lds
    ds_read_b128 a[212:215], v4 offset:12288
    s_waitcnt lgkmcnt(5)
    v_mfma_f32_32x32x16_bf16 v[16:31], v[92:95], a[192:195], v[16:31]
    ds_read_b128 a[216:219], v4 offset:13312
    s_waitcnt lgkmcnt(5)
    v_mfma_f32_32x32x16_bf16 v[16:31], v[96:99], a[196:199], v[16:31]
    ds_read_b128 a[192:195], v4 offset:14336
    s_waitcnt lgkmcnt(5)
    v_mfma_f32_32x32x16_bf16 v[16:31], v[100:103], a[200:203], v[16:31]
    buffer_load_dwordx4 v1, s[48:51], s62 offen offset:3072 sc1 lds
    ds_read_b128 a[196:199], v4 offset:15360
    s_waitcnt lgkmcnt(5)
    v_mfma_f32_32x32x16_bf16 v[16:31], v[104:107], a[204:207], v[16:31]
    s_waitcnt vmcnt(8)
    s_barrier
    ds_read_b128 a[200:203], v4 offset:16384
    s_waitcnt lgkmcnt(5)
    v_mfma_f32_32x32x16_bf16 v[16:31], v[108:111], a[208:211], v[16:31]
    ds_read_b128 a[204:207], v4 offset:17408
    s_waitcnt lgkmcnt(5)
    v_mfma_f32_32x32x16_bf16 v[16:31], v[112:115], a[212:215], v[16:31]
    s_add_u32 s62, s9, 49152
    s_add_u32 m0, s61, 65536
    s_nop 0
    buffer_load_dwordx4 v1, s[48:51], s62 offen offset:0 sc1 lds
    ds_read_b128 a[208:211], v4 offset:18432
    s_waitcnt lgkmcnt(5)
    v_mfma_f32_32x32x16_bf16 v[16:31], v[116:119], a[216:219], v[16:31]
    ds_read_b128 a[212:215], v4 offset:19456
    s_waitcnt lgkmcnt(5)
    v_mfma_f32_32x32x16_bf16 v[16:31], v[120:123], a[192:195], v[16:31]
    ds_read_b128 a[216:219], v4 offset:20480
    s_waitcnt lgkmcnt(5)
    v_mfma_f32_32x32x16_bf16 v[16:31], v[124:127], a[196:199], v[16:31]
    buffer_load_dwordx4 v1, s[48:51], s62 offen offset:1024 sc1 lds
    ds_read_b128 a[192:195], v4 offset:21504
    s_waitcnt lgkmcnt(5)
    v_mfma_f32_32x32x16_bf16 v[16:31], v[128:131], a[200:203], v[16:31]
    ds_read_b128 a[196:199], v4 offset:22528
    s_waitcnt lgkmcnt(5)
    v_mfma_f32_32x32x16_bf16 v[16:31], v[132:135], a[204:207], v[16:31]
    ds_read_b128 a[200:203], v4 offset:23552
    s_waitcnt lgkmcnt(5)
    v_mfma_f32_32x32x16_bf16 v[16:31], v[136:139], a[208:211], v[16:31]
    buffer_load_dwordx4 v1, s[48:51], s62 offen offset:2048 sc1 lds
    ds_read_b128 a[204:207], v4 offset:24576
    s_waitcnt lgkmcnt(5)
    v_mfma_f32_32x32x16_bf16 v[16:31], v[140:143], a[212:215], v[16:31]
    ds_read_b128 a[208:211], v4 offset:25600
    s_waitcnt lgkmcnt(5)
    v_mfma_f32_32x32x16_bf16 v[16:31], v[144:147], a[216:219], v[16:31]
    ds_read_b128 a[212:215], v4 offset:26624
    s_waitcnt lgkmcnt(5)
    v_mfma_f32_32x32x16_bf16 v[16:31], v[148:151], a[192:195], v[16:31]
    buffer_load_dwordx4 v1, s[48:51], s62 offen offset:3072 sc1 lds
    ds_read_b128 a[216:219], v4 offset:27648
    s_waitcnt lgkmcnt(5)
    v_mfma_f32_32x32x16_bf16 v[16:31], v[152:155], a[196:199], v[16:31]
    ds_read_b128 a[192:195], v4 offset:28672
    s_waitcnt lgkmcnt(5)
    v_mfma_f32_32x32x16_bf16 v[16:31], v[156:159], a[200:203], v[16:31]
    ds_read_b128 a[196:199], v4 offset:29696
    s_waitcnt lgkmcnt(5)
    v_mfma_f32_32x32x16_bf16 v[16:31], v[160:163], a[204:207], v[16:31]
    buffer_load_dwordx2 v[12:13], v9, s[48:51], 0 offen sc1
    s_add_u32 s62, s10, 49152
    s_add_u32 m0, s61, 81920
    s_nop 0
    buffer_load_dwordx4 v1, s[48:51], s62 offen offset:0 sc1 lds
    ds_read_b128 a[200:203], v4 offset:30720
    s_waitcnt lgkmcnt(5)
    v_mfma_f32_32x32x16_bf16 v[16:31], v[164:167], a[208:211], v[16:31]
    ds_read_b128 a[204:207], v4 offset:31744
    s_waitcnt lgkmcnt(5)
    v_mfma_f32_32x32x16_bf16 v[16:31], v[168:171], a[212:215], v[16:31]
    s_waitcnt vmcnt(10)
    s_barrier
    ds_read_b128 a[208:211], v4 offset:32768
    s_waitcnt lgkmcnt(5)
    v_mfma_f32_32x32x16_bf16 v[16:31], v[172:175], a[216:219], v[16:31]
    buffer_load_dwordx4 v1, s[48:51], s62 offen offset:1024 sc1 lds
    ds_read_b128 a[212:215], v4 offset:33792
    s_waitcnt lgkmcnt(5)
    v_mfma_f32_32x32x16_bf16 v[16:31], v[176:179], a[192:195], v[16:31]
    ds_read_b128 a[216:219], v4 offset:34816
    s_waitcnt lgkmcnt(5)
    v_mfma_f32_32x32x16_bf16 v[16:31], v[180:183], a[196:199], v[16:31]
    ds_read_b128 a[192:195], v4 offset:35840
    s_waitcnt lgkmcnt(5)
    v_mfma_f32_32x32x16_bf16 v[16:31], v[184:187], a[200:203], v[16:31]
    buffer_load_dwordx4 v1, s[48:51], s62 offen offset:2048 sc1 lds
    ds_read_b128 a[196:199], v4 offset:36864
    s_waitcnt lgkmcnt(5)
    v_mfma_f32_32x32x16_bf16 v[16:31], v[188:191], a[204:207], v[16:31]
    ds_read_b128 a[200:203], v4 offset:37888
    s_waitcnt lgkmcnt(5)
    v_mfma_f32_32x32x16_bf16 v[16:31], v[192:195], a[208:211], v[16:31]
    ds_read_b128 a[204:207], v4 offset:38912
    s_waitcnt lgkmcnt(5)
    v_mfma_f32_32x32x16_bf16 v[16:31], v[196:199], a[212:215], v[16:31]
    buffer_load_dwordx4 v1, s[48:51], s62 offen offset:3072 sc1 lds
    ds_read_b128 a[208:211], v4 offset:39936
    s_waitcnt lgkmcnt(5)
    v_mfma_f32_32x32x16_bf16 v[16:31], v[200:203], a[216:219], v[16:31]
    ds_read_b128 a[212:215], v4 offset:40960
    s_waitcnt lgkmcnt(5)
    v_mfma_f32_32x32x16_bf16 v[16:31], v[204:207], a[192:195], v[16:31]
    ds_read_b128 a[216:219], v4 offset:41984
    s_waitcnt lgkmcnt(5)
    v_mfma_f32_32x32x16_bf16 v[16:31], v[208:211], a[196:199], v[16:31]
    s_mul_i32 s57, s64, 3072
    s_mul_i32 s58, s66, 384
    s_add_u32 s57, s57, s58
    s_add_u32 s57, s57, 19398656
    buffer_load_dwordx4 a[232:235], v15, s[48:51], s57 offen offset:0 sc1
    ds_read_b128 a[192:195], v4 offset:43008
    s_waitcnt lgkmcnt(5)
    v_mfma_f32_32x32x16_bf16 v[16:31], v[212:215], a[200:203], v[16:31]
    ds_read_b128 a[196:199], v4 offset:44032
    s_waitcnt lgkmcnt(5)
    v_mfma_f32_32x32x16_bf16 v[16:31], v[216:219], a[204:207], v[16:31]
    ds_read_b128 a[200:203], v4 offset:45056
    s_waitcnt lgkmcnt(5)
    v_mfma_f32_32x32x16_bf16 v[16:31], v[220:223], a[208:211], v[16:31]
    buffer_load_dwordx4 a[236:239], v11, s[48:51], s57 offen offset:256 sc1
    ds_read_b128 a[204:207], v4 offset:46080
    s_waitcnt lgkmcnt(5)
    v_mfma_f32_32x32x16_bf16 v[16:31], v[224:227], a[212:215], v[16:31]
    ds_read_b128 a[208:211], v4 offset:47104
    s_waitcnt lgkmcnt(5)
    v_mfma_f32_32x32x16_bf16 v[16:31], v[228:231], a[216:219], v[16:31]
    ds_read_b128 a[212:215], v4 offset:48128
    s_waitcnt lgkmcnt(5)
    v_mfma_f32_32x32x16_bf16 v[16:31], v[232:235], a[192:195], v[16:31]
    s_waitcnt vmcnt(11)
    s_barrier
    ds_read_b128 a[216:219], v4 offset:49152
    s_waitcnt lgkmcnt(5)
    v_mfma_f32_32x32x16_bf16 v[16:31], v[236:239], a[196:199], v[16:31]
    ds_read_b128 a[192:195], v4 offset:50176
    s_waitcnt lgkmcnt(5)
    v_mfma_f32_32x32x16_bf16 v[16:31], v[240:243], a[200:203], v[16:31]
    ds_read_b128 a[196:199], v4 offset:51200
    s_waitcnt lgkmcnt(5)
    v_mfma_f32_32x32x16_bf16 v[16:31], v[244:247], a[204:207], v[16:31]
    ds_read_b128 a[200:203], v4 offset:52224
    s_waitcnt lgkmcnt(5)
    v_mfma_f32_32x32x16_bf16 v[16:31], v[248:251], a[208:211], v[16:31]
    s_waitcnt vmcnt(6)
    v_cmp_ne_u64 vcc, v[12:13], v[2:3]
    s_cbranch_vccz L_vok_53
    s_mov_b32 s88, 0
    s_mov_b64 exec, -1
L_spin_54:
    buffer_load_dwordx2 v[12:13], v9, s[48:51], 0 offen sc1
    s_waitcnt vmcnt(0)
    v_cmp_ne_u64 vcc, v[12:13], v[2:3]
    s_cbranch_vccz L_spun_55
    s_add_u32 s88, s88, 1
    s_cmp_lt_u32 s88, 262144
    s_cbranch_scc1 L_spin_54
L_spun_55:
    s_mov_b64 exec, -1
L_vok_53:
    ds_read_b128 a[204:207], v4 offset:53248
    s_waitcnt lgkmcnt(5)
    v_mfma_f32_32x32x16_bf16 v[16:31], v[252:255], a[212:215], v[16:31]
    ds_read_b128 a[208:211], v4 offset:54272
    s_waitcnt lgkmcnt(5)
    v_mfma_f32_32x32x16_bf16 v[32:47], v[64:67], a[216:219], 0
    ds_read_b128 a[212:215], v4 offset:55296
    s_waitcnt lgkmcnt(5)
    v_mfma_f32_32x32x16_bf16 v[32:47], v[68:71], a[192:195], v[32:47]
    s_add_u32 s59, s67, 0
    buffer_load_dwordx4 a[0:3], v1, s[48:51], s59 offen offset:0 sc1
    ds_read_b128 a[216:219], v4 offset:56320
    s_waitcnt lgkmcnt(5)
    v_mfma_f32_32x32x16_bf16 v[32:47], v[72:75], a[196:199], v[32:47]
    ds_read_b128 a[192:195], v4 offset:57344
    s_waitcnt lgkmcnt(5)
    v_mfma_f32_32x32x16_bf16 v[32:47], v[76:79], a[200:203], v[32:47]
    v_max3_f32 v48, v16, v17, v18
    v_max3_f32 v49, v19, v20, v21
    v_max3_f32 v48, v48, v22, v23
    ds_read_b128 a[196:199], v4 offset:58368
    s_waitcnt lgkmcnt(5)
    v_mfma_f32_32x32x16_bf16 v[32:47], v[80:83], a[204:207], v[32:47]
    v_max3_f32 v49, v49, v24, v25
    v_max3_f32 v48, v48, v26, v27
    v_max3_f32 v49, v49, v28, v29
    buffer_load_dwordx4 a[4:7], v1, s[48:51], s59 offen offset:1024 sc1
    ds_read_b128 a[200:203], v4 offset:59392
    s_waitcnt lgkmcnt(5)
    v_mfma_f32_32x32x16_bf16 v[32:47], v[84:87], a[208:211], v[32:47]
    v_max3_f32 v48, v48, v30, v31
    v_max_f32 v48, v48, v49
    v_mov_b32 v49, v48
    ds_read_b128 a[204:207], v4 offset:60416
    s_waitcnt lgkmcnt(5)
    v_mfma_f32_32x32x16_bf16 v[32:47], v[88:91], a[212:215], v[32:47]
    v_permlane32_swap_b32 v49, v48
    v_max_f32 v48, v48, v49
    ds_write_b32 v6, v48 offset:0
    ds_read_b128 a[208:211], v4 offset:61440
    s_waitcnt lgkmcnt(6)
    v_mfma_f32_32x32x16_bf16 v[32:47], v[92:95], a[216:219], v[32:47]
    s_waitcnt lgkmcnt(1)
    s_barrier
    ds_read_b128 v[56:59], v7 offset:0
    s_waitcnt lgkmcnt(0)
    v_max3_f32 v50, v56, v57, v58
    buffer_load_dwordx4 a[8:11], v1, s[48:51], s59 offen offset:2048 sc1
    ds_read_b128 a[212:215], v4 offset:62464
    v_mfma_f32_32x32x16_bf16 v[32:47], v[96:99], a[192:195], v[32:47]
    v_max_f32 v50, v50, v59
    v_pk_add_f32 v[16:17], v[16:17], v[50:51] op_sel_hi:[1,0] neg_lo:[0,1] neg_hi:[0,1]
    v_pk_add_f32 v[18:19], v[18:19], v[50:51] op_sel_hi:[1,0] neg_lo:[0,1] neg_hi:[0,1]
    ds_read_b128 a[216:219], v4 offset:63488
    v_mfma_f32_32x32x16_bf16 v[32:47], v[100:103], a[196:199], v[32:47]
    v_pk_add_f32 v[20:21], v[20:21], v[50:51] op_sel_hi:[1,0] neg_lo:[0,1] neg_hi:[0,1]
    v_pk_add_f32 v[22:23], v[22:23], v[50:51] op_sel_hi:[1,0] neg_lo:[0,1] neg_hi:[0,1]
    v_pk_add_f32 v[24:25], v[24:25], v[50:51] op_sel_hi:[1,0] neg_lo:[0,1] neg_hi:[0,1]
    ds_read_b128 a[192:195], v4 offset:64512
    v_mfma_f32_32x32x16_bf16 v[32:47], v[104:107], a[200:203], v[32:47]
    v_pk_add_f32 v[26:27], v[26:27], v[50:51] op_sel_hi:[1,0] neg_lo:[0,1] neg_hi:[0,1]
    v_pk_add_f32 v[28:29], v[28:29], v[50:51] op_sel_hi:[1,0] neg_lo:[0,1] neg_hi:[0,1]
    v_pk_add_f32 v[30:31], v[30:31], v[50:51] op_sel_hi:[1,0] neg_lo:[0,1] neg_hi:[0,1]
    buffer_load_dwordx4 a[12:15], v1, s[48:51], s59 offen offset:3072 sc1
    s_barrier
    ds_read_b128 a[196:199], v5 offset:0
    v_mfma_f32_32x32x16_bf16 v[32:47], v[108:111], a[204:207], v[32:47]
    v_exp_f32 v16, v16
    v_exp_f32 v17, v17
    v_exp_f32 v18, v18
    ds_read_b128 a[200:203], v5 offset:1024
    v_mfma_f32_32x32x16_bf16 v[32:47], v[112:115], a[208:211], v[32:47]
    v_exp_f32 v19, v19
    v_exp_f32 v20, v20
    v_exp_f32 v21, v21
    ds_read_b128 a[204:207], v5 offset:2048
    s_waitcnt lgkmcnt(5)
    v_mfma_f32_32x32x16_bf16 v[32:47], v[116:119], a[212:215], v[32:47]
    v_exp_f32 v22, v22
    v_exp_f32 v23, v23
    v_exp_f32 v24, v24
    s_add_u32 s59, s67, 4096
    buffer_load_dwordx4 a[16:19], v1, s[48:51], s59 offen offset:0 sc1
    ds_read_b128 a[208:211], v5 offset:3072
    s_waitcnt lgkmcnt(5)
    v_mfma_f32_32x32x16_bf16 v[32:47], v[120:123], a[216:219], v[32:47]
    v_exp_f32 v25, v25
    v_exp_f32 v26, v26
    v_exp_f32 v27, v27
    ds_read_b128 a[212:215], v5 offset:4096
    s_waitcnt lgkmcnt(5)
    v_mfma_f32_32x32x16_bf16 v[32:47], v[124:127], a[192:195], v[32:47]
    v_exp_f32 v28, v28
    v_exp_f32 v29, v29
    v_exp_f32 v30, v30
    ds_read_b128 a[216:219], v5 offset:5120
    s_waitcnt lgkmcnt(5)
    v_mfma_f32_32x32x16_bf16 v[32:47], v[128:131], a[196:199], v[32:47]
    v_exp_f32 v31, v31
    v_pk_add_f32 v[48:49], v[16:17], v[18:19]
    v_pk_add_f32 v[56:57], v[20:21], v[22:23]
    buffer_load_dwordx4 a[20:23], v1, s[48:51], s59 offen offset:1024 sc1
    ds_read_b128 a[192:195], v5 offset:6144
    s_waitcnt lgkmcnt(5)
    v_mfma_f32_32x32x16_bf16 v[32:47], v[132:135], a[200:203], v[32:47]
    v_pk_add_f32 v[48:49], v[48:49], v[24:25]
    v_pk_add_f32 v[56:57], v[56:57], v[26:27]
    v_pk_add_f32 v[48:49], v[48:49], v[28:29]
    ds_read_b128 a[196:199], v5 offset:7168
    s_waitcnt lgkmcnt(5)
    v_mfma_f32_32x32x16_bf16 v[32:47], v[136:139], a[204:207], v[32:47]
    v_pk_add_f32 v[56:57], v[56:57], v[30:31]
    v_pk_add_f32 v[48:49], v[48:49], v[56:57]
    v_cvt_pk_bf16_f32 v16, v16, v17
    ds_read_b128 a[200:203], v5 offset:8192
    s_waitcnt lgkmcnt(5)
    v_mfma_f32_32x32x16_bf16 v[32:47], v[140:143], a[208:211], v[32:47]
    v_cvt_pk_bf16_f32 v17, v18, v19
    v_cvt_pk_bf16_f32 v18, v20, v21
    v_cvt_pk_bf16_f32 v19, v22, v23
    buffer_load_dwordx4 a[24:27], v1, s[48:51], s59 offen offset:2048 sc1
    ds_read_b128 a[204:207], v5 offset:9216
    s_waitcnt lgkmcnt(5)
    v_mfma_f32_32x32x16_bf16 v[32:47], v[144:147], a[212:215], v[32:47]
    s_add_u32 s58, s68, 0
    buffer_store_dwordx4 v[16:19], v1, s[48:51], s58 offen offset:0 sc1
    v_cvt_pk_bf16_f32 v24, v24, v25
    v_cvt_pk_bf16_f32 v25, v26, v27
    ds_read_b128 a[208:211], v5 offset:10240
    s_waitcnt lgkmcnt(5)
    v_mfma_f32_32x32x16_bf16 v[32:47], v[148:151], a[216:219], v[32:47]
    v_cvt_pk_bf16_f32 v26, v28, v29
    v_cvt_pk_bf16_f32 v27, v30, v31
    buffer_store_dwordx4 v[24:27], v1, s[48:51], s58 offen offset:1024 sc1
    ds_read_b128 a[212:215], v5 offset:11264
    s_waitcnt lgkmcnt(5)
    v_mfma_f32_32x32x16_bf16 v[32:47], v[152:155], a[192:195], v[32:47]
    v_add_f32 v48, v48, v49
    v_mov_b32 v49, v48
    s_nop 1
    v_permlane32_swap_b32 v49, v48
    buffer_load_dwordx4 a[28:31], v1, s[48:51], s59 offen offset:3072 sc1
    ds_read_b128 a[216:219], v5 offset:12288
    s_waitcnt lgkmcnt(5)
    v_mfma_f32_32x32x16_bf16 v[32:47], v[156:159], a[196:199], v[32:47]
    v_add_f32 v51, v48, v49
    s_add_u32 s58, s94, 0
    s_mov_b32 exec_hi, 0
    buffer_store_dwordx2 v[50:51], v8, s[48:51], s58 offen sc1
    s_mov_b32 exec_hi, -1
    ds_read_b128 a[192:195], v5 offset:13312
    s_waitcnt lgkmcnt(5)
    v_mfma_f32_32x32x16_bf16 v[32:47], v[160:163], a[200:203], v[32:47]
    ds_read_b128 a[196:199], v5 offset:14336
    s_waitcnt lgkmcnt(5)
    v_mfma_f32_32x32x16_bf16 v[32:47], v[164:167], a[204:207], v[32:47]
    s_add_u32 s59, s67, 8192
    buffer_load_dwordx4 a[32:35], v1, s[48:51], s59 offen offset:0 sc1
    ds_read_b128 a[200:203], v5 offset:15360
    s_waitcnt lgkmcnt(5)
    v_mfma_f32_32x32x16_bf16 v[32:47], v[168:171], a[208:211], v[32:47]
    s_waitcnt vmcnt(14)
    s_barrier
    ds_read_b128 a[204:207], v5 offset:16384
    s_waitcnt lgkmcnt(5)
    v_mfma_f32_32x32x16_bf16 v[32:47], v[172:175], a[212:215], v[32:47]
    ds_read_b128 a[208:211], v5 offset:17408
    s_waitcnt lgkmcnt(5)
    v_mfma_f32_32x32x16_bf16 v[32:47], v[176:179], a[216:219], v[32:47]
    buffer_load_dwordx4 a[36:39], v1, s[48:51], s59 offen offset:1024 sc1
    ds_read_b128 a[212:215], v5 offset:18432
    s_waitcnt lgkmcnt(5)
    v_mfma_f32_32x32x16_bf16 v[32:47], v[180:183], a[192:195], v[32:47]
    ds_read_b128 a[216:219], v5 offset:19456
    s_waitcnt lgkmcnt(5)
    v_mfma_f32_32x32x16_bf16 v[32:47], v[184:187], a[196:199], v[32:47]
    ds_read_b128 a[192:195], v5 offset:20480
    s_waitcnt lgkmcnt(5)
    v_mfma_f32_32x32x16_bf16 v[32:47], v[188:191], a[200:203], v[32:47]
    buffer_load_dwordx4 a[40:43], v1, s[48:51], s59 offen offset:2048 sc1
    ds_read_b128 a[196:199], v5 offset:21504
    s_waitcnt lgkmcnt(5)
    v_mfma_f32_32x32x16_bf16 v[32:47], v[192:195], a[204:207], v[32:47]
    ds_read_b128 a[200:203], v5 offset:22528
    s_waitcnt lgkmcnt(5)
    v_mfma_f32_32x32x16_bf16 v[32:47], v[196:199], a[208:211], v[32:47]
    ds_read_b128 a[204:207], v5 offset:23552
    s_waitcnt lgkmcnt(5)
    v_mfma_f32_32x32x16_bf16 v[32:47], v[200:203], a[212:215], v[32:47]
    buffer_load_dwordx4 a[44:47], v1, s[48:51], s59 offen offset:3072 sc1
    ds_read_b128 a[208:211], v5 offset:24576
    s_waitcnt lgkmcnt(5)
    v_mfma_f32_32x32x16_bf16 v[32:47], v[204:207], a[216:219], v[32:47]
    ds_read_b128 a[212:215], v5 offset:25600
    s_waitcnt lgkmcnt(5)
    v_mfma_f32_32x32x16_bf16 v[32:47], v[208:211], a[192:195], v[32:47]
    ds_read_b128 a[216:219], v5 offset:26624
    s_waitcnt lgkmcnt(5)
    v_mfma_f32_32x32x16_bf16 v[32:47], v[212:215], a[196:199], v[32:47]
    s_add_u32 s59, s67, 12288
    buffer_load_dwordx4 a[48:51], v1, s[48:51], s59 offen offset:0 sc1
    ds_read_b128 a[192:195], v5 offset:27648
    s_waitcnt lgkmcnt(5)
    v_mfma_f32_32x32x16_bf16 v[32:47], v[216:219], a[200:203], v[32:47]
    ds_read_b128 a[196:199], v5 offset:28672
    s_waitcnt lgkmcnt(5)
    v_mfma_f32_32x32x16_bf16 v[32:47], v[220:223], a[204:207], v[32:47]
    ds_read_b128 a[200:203], v5 offset:29696
    s_waitcnt lgkmcnt(5)
    v_mfma_f32_32x32x16_bf16 v[32:47], v[224:227], a[208:211], v[32:47]
    buffer_load_dwordx4 a[52:55], v1, s[48:51], s59 offen offset:1024 sc1
    ds_read_b128 a[204:207], v5 offset:30720
    s_waitcnt lgkmcnt(5)
    v_mfma_f32_32x32x16_bf16 v[32:47], v[228:231], a[212:215], v[32:47]
    ds_read_b128 a[208:211], v5 offset:31744
    s_waitcnt lgkmcnt(5)
    v_mfma_f32_32x32x16_bf16 v[32:47], v[232:235], a[216:219], v[32:47]
    s_waitcnt lgkmcnt(4)
    v_mfma_f32_32x32x16_bf16 v[32:47], v[236:239], a[192:195], v[32:47]
    buffer_load_dwordx4 a[56:59], v1, s[48:51], s59 offen offset:2048 sc1
    s_waitcnt lgkmcnt(3)
    v_mfma_f32_32x32x16_bf16 v[32:47], v[240:243], a[196:199], v[32:47]
    s_waitcnt lgkmcnt(2)
    v_mfma_f32_32x32x16_bf16 v[32:47], v[244:247], a[200:203], v[32:47]
    s_waitcnt lgkmcnt(1)
    v_mfma_f32_32x32x16_bf16 v[32:47], v[248:251], a[204:207], v[32:47]
    buffer_load_dwordx4 a[60:63], v1, s[48:51], s59 offen offset:3072 sc1
    s_waitcnt lgkmcnt(0)
    v_mfma_f32_32x32x16_bf16 v[32:47], v[252:255], a[208:211], v[32:47]
    s_nop 11
    v_max3_f32 v48, v32, v33, v34
    v_max3_f32 v49, v35, v36, v37
    v_max3_f32 v48, v48, v38, v39
    v_max3_f32 v49, v49, v40, v41
    v_max3_f32 v48, v48, v42, v43
    s_add_u32 s59, s67, 65536
    buffer_load_dwordx4 a[64:67], v1, s[48:51], s59 offen offset:0 sc1
    v_max3_f32 v49, v49, v44, v45
    v_max3_f32 v48, v48, v46, v47
    v_max_f32 v48, v48, v49
    v_mov_b32 v49, v48
    s_nop 1
    v_permlane32_swap_b32 v49, v48
    buffer_load_dwordx4 a[68:71], v1, s[48:51], s59 offen offset:1024 sc1
    v_max_f32 v48, v48, v49
    ds_write_b32 v6, v48 offset:512
    s_waitcnt lgkmcnt(0)
    s_barrier
    ds_read_b128 v[56:59], v7 offset:512
    s_waitcnt lgkmcnt(0)
    v_max3_f32 v52, v56, v57, v58
    buffer_load_dwordx4 a[72:75], v1, s[48:51], s59 offen offset:2048 sc1
    v_max_f32 v52, v52, v59
    v_pk_add_f32 v[32:33], v[32:33], v[52:53] op_sel_hi:[1,0] neg_lo:[0,1] neg_hi:[0,1]
    v_pk_add_f32 v[34:35], v[34:35], v[52:53] op_sel_hi:[1,0] neg_lo:[0,1] neg_hi:[0,1]
    v_pk_add_f32 v[36:37], v[36:37], v[52:53] op_sel_hi:[1,0] neg_lo:[0,1] neg_hi:[0,1]
    v_pk_add_f32 v[38:39], v[38:39], v[52:53] op_sel_hi:[1,0] neg_lo:[0,1] neg_hi:[0,1]
    buffer_load_dwordx4 a[76:79], v1, s[48:51], s59 offen offset:3072 sc1
    v_pk_add_f32 v[40:41], v[40:41], v[52:53] op_sel_hi:[1,0] neg_lo:[0,1] neg_hi:[0,1]
    v_pk_add_f32 v[42:43], v[42:43], v[52:53] op_sel_hi:[1,0] neg_lo:[0,1] neg_hi:[0,1]
    v_pk_add_f32 v[44:45], v[44:45], v[52:53] op_sel_hi:[1,0] neg_lo:[0,1] neg_hi:[0,1]
    v_pk_add_f32 v[46:47], v[46:47], v[52:53] op_sel_hi:[1,0] neg_lo:[0,1] neg_hi:[0,1]
    v_exp_f32 v32, v32
    s_add_u32 s59, s67, 69632
    buffer_load_dwordx4 a[80:83], v1, s[48:51], s59 offen offset:0 sc1
    v_exp_f32 v33, v33
    v_exp_f32 v34, v34
    v_exp_f32 v35, v35
    v_exp_f32 v36, v36
    v_exp_f32 v37, v37
    buffer_load_dwordx4 a[84:87], v1, s[48:51], s59 offen offset:1024 sc1
    v_exp_f32 v38, v38
    v_exp_f32 v39, v39
    v_exp_f32 v40, v40
    v_exp_f32 v41, v41
    v_exp_f32 v42, v42
    buffer_load_dwordx4 a[88:91], v1, s[48:51], s59 offen offset:2048 sc1
    v_exp_f32 v43, v43
    v_exp_f32 v44, v44
    v_exp_f32 v45, v45
    v_exp_f32 v46, v46
    v_exp_f32 v47, v47
    buffer_load_dwordx4 a[92:95], v1, s[48:51], s59 offen offset:3072 sc1
    v_pk_add_f32 v[48:49], v[32:33], v[34:35]
    v_pk_add_f32 v[56:57], v[36:37], v[38:39]
    v_pk_add_f32 v[48:49], v[48:49], v[40:41]
    v_pk_add_f32 v[56:57], v[56:57], v[42:43]
    v_pk_add_f32 v[48:49], v[48:49], v[44:45]
    s_add_u32 s59, s67, 73728
    buffer_load_dwordx4 a[96:99], v1, s[48:51], s59 offen offset:0 sc1
    v_pk_add_f32 v[56:57], v[56:57], v[46:47]
    v_pk_add_f32 v[48:49], v[48:49], v[56:57]
    v_cvt_pk_bf16_f32 v32, v32, v33
    v_cvt_pk_bf16_f32 v33, v34, v35
    v_cvt_pk_bf16_f32 v34, v36, v37
    buffer_load_dwordx4 a[100:103], v1, s[48:51], s59 offen offset:1024 sc1
    v_cvt_pk_bf16_f32 v35, v38, v39
    s_add_u32 s58, s68, 65536
    buffer_store_dwordx4 v[32:35], v1, s[48:51], s58 offen offset:0 sc1
    v_cvt_pk_bf16_f32 v40, v40, v41
    v_cvt_pk_bf16_f32 v41, v42, v43
    v_cvt_pk_bf16_f32 v42, v44, v45
    buffer_load_dwordx4 a[104:107], v1, s[48:51], s59 offen offset:2048 sc1
    v_cvt_pk_bf16_f32 v43, v46, v47
    buffer_store_dwordx4 v[40:43], v1, s[48:51], s58 offen offset:1024 sc1
    v_add_f32 v48, v48, v49
    v_mov_b32 v49, v48
    s_nop 1
    v_permlane32_swap_b32 v49, v48
    buffer_load_dwordx4 a[108:111], v1, s[48:51], s59 offen offset:3072 sc1
    v_add_f32 v53, v48, v49
    s_add_u32 s58, s94, 8192
    s_mov_b32 exec_hi, 0
    buffer_store_dwordx2 v[52:53], v8, s[48:51], s58 offen sc1
    s_mov_b32 exec_hi, -1
    s_waitcnt vmcnt(23)
    s_mov_b64 exec, 1
    buffer_store_dwordx2 v[2:3], off, s[48:51], s95 sc1
    s_mov_b64 exec, -1
    s_add_u32 s59, s67, 77824
    buffer_load_dwordx4 a[112:115], v1, s[48:51], s59 offen offset:0 sc1
    buffer_load_dwordx4 a[116:119], v1, s[48:51], s59 offen offset:1024 sc1
    buffer_load_dwordx4 a[120:123], v1, s[48:51], s59 offen offset:2048 sc1
    buffer_load_dwordx4 a[124:127], v1, s[48:51], s59 offen offset:3072 sc1
    s_add_u32 s59, s67, 131072
    buffer_load_dwordx4 a[128:131], v1, s[48:51], s59 offen offset:0 sc1
    buffer_load_dwordx4 a[132:135], v1, s[48:51], s59 offen offset:1024 sc1
    buffer_load_dwordx4 a[136:139], v1, s[48:51], s59 offen offset:2048 sc1
    buffer_load_dwordx4 a[140:143], v1, s[48:51], s59 offen offset:3072 sc1
    s_lshl_b32 s56, s64, 5
    s_lshl_b32 s57, s65, 1
    s_add_u32 s56, s56, s57
    s_lshl_b32 s57, s56, 6
    s_lshl_b32 s58, s3, 4
    s_add_u32 s57, s57, s58
    s_lshl_b32 s57, s57, 10
    s_add_u32 s60, s57, 14680064
    s_lshl_b32 s57, s56, 3
    s_lshl_b32 s58, s3, 1
    s_add_u32 s57, s57, s58
    s_lshl_b32 s61, s57, 10
    s_add_u32 s61, s61, 18874368
    s_lshl_b32 s57, s57, 5
    s_add_u32 s57, s57, 19566592
    v_lshlrev_b32 v9, 3, v0
    v_add_u32 v9, s57, v9
    v_lshrrev_b32 v60, 5, v0
    v_lshl_add_u32 v8, v60, 10, v8
    v_lshlrev_b32 v61, 1, v60
    v_xor_b32 v61, v61, v0
    s_mul_i32 s56, s3, 24576
    v_xor_b32 v62, 0, v61
    v_lshlrev_b32 v62, 4, v62
    v_add_u32 v62, s56, v62
    v_add_u32 v4, 0, v62
    v_xor_b32 v62, 4, v61
    v_lshlrev_b32 v62, 4, v62
    v_add_u32 v62, s56, v62
    v_add_u32 v5, 1024, v62
    v_xor_b32 v62, 8, v61
    v_lshlrev_b32 v62, 4, v62
    v_add_u32 v62, s56, v62
    v_add_u32 v6, 2048, v62
    v_xor_b32 v62, 12, v61
    v_lshlrev_b32 v62, 4, v62
    v_add_u32 v62, s56, v62
    v_add_u32 v7, 3072, v62
    v_and_b32 v60, 1, v0
    v_lshrrev_b32 v61, 1, v0
    v_and_b32 v61, 3, v61
    v_lshl_add_u32 v62, v60, 5, v14
    v_lshlrev_b32 v63, 2, v61
    v_xor_b32 v62, v62, v63
    v_lshlrev_b32 v63, 1, v60
    v_xor_b32 v62, v62, v63
    v_lshlrev_b32 v62, 4, v62
    v_lshl_add_u32 v11, v61, 10, v62
    v_add_u32 v15, 49152, v11
    v_lshlrev_b32 v14, 5, v14
    v_add_u32 v14, 99328, v14
    v_accvgpr_read_b32 v16, a232
    v_accvgpr_read_b32 v24, a236
    v_accvgpr_read_b32 v17, a233
    v_accvgpr_read_b32 v25, a237
    v_accvgpr_read_b32 v18, a234
    v_accvgpr_read_b32 v26, a238
    v_accvgpr_read_b32 v19, a235
    v_accvgpr_read_b32 v27, a239
    v_accvgpr_read_b32 v28, a220
    v_accvgpr_read_b32 v29, a221
    v_accvgpr_read_b32 v30, a222
    v_accvgpr_read_b32 v31, a223
    v_accvgpr_read_b32 v32, a224
    v_accvgpr_read_b32 v33, a225
    v_accvgpr_read_b32 v34, a226
    v_accvgpr_read_b32 v35, a227
    v_accvgpr_read_b32 v36, a228
    v_accvgpr_read_b32 v37, a229
    v_accvgpr_read_b32 v38, a230
    v_accvgpr_read_b32 v39, a231
    v_add_f32_dpp v16, v16, v16 row_ror:8 row_mask:0xf bank_mask:0xf
    v_add_f32_dpp v17, v17, v17 row_ror:8 row_mask:0xf bank_mask:0xf
    v_add_f32_dpp v18, v18, v18 row_ror:8 row_mask:0xf bank_mask:0xf
    v_add_f32_dpp v19, v19, v19 row_ror:8 row_mask:0xf bank_mask:0xf
    v_add_f32_dpp v24, v24, v24 row_ror:8 row_mask:0xf bank_mask:0xf
    v_add_f32_dpp v25, v25, v25 row_ror:8 row_mask:0xf bank_mask:0xf
    v_add_f32_dpp v26, v26, v26 row_ror:8 row_mask:0xf bank_mask:0xf
    v_add_f32_dpp v27, v27, v27 row_ror:8 row_mask:0xf bank_mask:0xf
    v_mov_b32 v40, v16
    v_mov_b32 v41, v17
    v_mov_b32 v42, v18
    v_mov_b32 v43, v19
    v_mov_b32 v44, v24
    v_mov_b32 v45, v25
    v_mov_b32 v46, v26
    v_mov_b32 v47, v27
    v_permlane16_swap_b32 v16, v40
    v_permlane16_swap_b32 v17, v41
    v_permlane16_swap_b32 v18, v42
    v_permlane16_swap_b32 v19, v43
    v_permlane16_swap_b32 v24, v44
    v_permlane16_swap_b32 v25, v45
    v_permlane16_swap_b32 v26, v46
    v_permlane16_swap_b32 v27, v47
    v_add_f32 v16, v16, v40
    v_add_f32 v17, v17, v41
    v_add_f32 v18, v18, v42
    v_add_f32 v19, v19, v43
    v_add_f32 v24, v24, v44
    v_add_f32 v25, v25, v45
    v_add_f32 v26, v26, v46
    v_add_f32 v27, v27, v47
    v_mov_b32 v20, v16
    v_mov_b32 v21, v17
    v_mov_b32 v22, v18
    v_mov_b32 v23, v19
    v_permlane32_swap_b32 v16, v20
    v_permlane32_swap_b32 v17, v21
    v_permlane32_swap_b32 v18, v22
    v_permlane32_swap_b32 v19, v23
    v_and_b32 v63, 31, v0
    v_lshlrev_b32 v63, 5, v63
    s_lshl_b32 s56, s3, 3
    s_add_u32 s56, s56, 99328
    v_add_u32 v63, s56, v63
    s_waitcnt vmcnt(9)
    s_add_u32 s95, s95, 256
    s_mov_b64 exec, 1
    buffer_store_dwordx2 v[2:3], off, s[48:51], s95 sc1
    s_mov_b64 exec, -1
    s_add_u32 s59, s67, 135168
    buffer_load_dwordx4 a[144:147], v1, s[48:51], s59 offen offset:0 sc1
    buffer_load_dwordx4 a[148:151], v1, s[48:51], s59 offen offset:1024 sc1
    buffer_load_dwordx4 a[152:155], v1, s[48:51], s59 offen offset:2048 sc1
    buffer_load_dwordx4 a[156:159], v1, s[48:51], s59 offen offset:3072 sc1
    s_add_u32 s59, s67, 139264
    buffer_load_dwordx4 a[160:163], v1, s[48:51], s59 offen offset:0 sc1
    buffer_load_dwordx4 a[164:167], v1, s[48:51], s59 offen offset:1024 sc1
    s_mov_b64 exec, 0xff
    buffer_load_dwordx2 v[12:13], v9, s[48:51], 0 offen sc1
    s_mov_b64 exec, -1
    buffer_load_dwordx4 a[168:171], v1, s[48:51], s59 offen offset:2048 sc1
    buffer_load_dwordx4 a[172:175], v1, s[48:51], s59 offen offset:3072 sc1
    s_add_u32 s59, s67, 143360
    buffer_load_dwordx4 a[176:179], v1, s[48:51], s59 offen offset:0 sc1
    buffer_load_dwordx4 a[180:183], v1, s[48:51], s59 offen offset:1024 sc1
    buffer_load_dwordx4 a[184:187], v1, s[48:51], s59 offen offset:2048 sc1
    buffer_load_dwordx4 a[188:191], v1, s[48:51], s59 offen offset:3072 sc1
    s_waitcnt vmcnt(6)
    s_mov_b64 exec, 0xff
    v_cmp_ne_u64 vcc, v[12:13], v[2:3]
    s_cbranch_vccz L_p0ok_56
    s_mov_b32 s88, 0
    s_mov_b64 exec, 0xff
L_spin_57:
    buffer_load_dwordx2 v[12:13], v9, s[48:51], 0 offen sc1
    s_waitcnt vmcnt(0)
    v_cmp_ne_u64 vcc, v[12:13], v[2:3]
    s_cbranch_vccz L_spun_58
    s_add_u32 s88, s88, 1
    s_cmp_lt_u32 s88, 262144
    s_cbranch_scc1 L_spin_57
L_spun_58:
    s_mov_b64 exec, -1
L_p0ok_56:
    s_mov_b64 exec, -1
    s_add_u32 s62, s61, 0
    buffer_load_dwordx2 v[40:41], v8, s[48:51], s62 offen offset:0 sc1
    buffer_load_dwordx2 v[42:43], v8, s[48:51], s62 offen offset:256 sc1
    buffer_load_dwordx2 v[44:45], v8, s[48:51], s62 offen offset:512 sc1
    buffer_load_dwordx2 v[46:47], v8, s[48:51], s62 offen offset:768 sc1
    s_add_u32 s62, s60, 0
    buffer_load_dwordx4 v[64:67], v1, s[48:51], s62 offen offset:0 sc1
    s_add_u32 s63, s60, 8192
    buffer_load_dwordx4 v[96:99], v1, s[48:51], s63 offen offset:0 sc1
    buffer_load_dwordx4 v[68:71], v1, s[48:51], s62 offen offset:1024 sc1
    buffer_load_dwordx4 v[100:103], v1, s[48:51], s63 offen offset:1024 sc1
    buffer_load_dwordx4 v[72:75], v1, s[48:51], s62 offen offset:2048 sc1
    buffer_load_dwordx4 v[104:107], v1, s[48:51], s63 offen offset:2048 sc1
    buffer_load_dwordx4 v[76:79], v1, s[48:51], s62 offen offset:3072 sc1
    buffer_load_dwordx4 v[108:111], v1, s[48:51], s63 offen offset:3072 sc1
    s_add_u32 s62, s60, 4096
    buffer_load_dwordx4 v[80:83], v1, s[48:51], s62 offen offset:0 sc1
    s_add_u32 s63, s60, 12288
    buffer_load_dwordx4 v[112:115], v1, s[48:51], s63 offen offset:0 sc1
    buffer_load_dwordx4 v[84:87], v1, s[48:51], s62 offen offset:1024 sc1
    buffer_load_dwordx4 v[116:119], v1, s[48:51], s63 offen offset:1024 sc1
    buffer_load_dwordx4 v[88:91], v1, s[48:51], s62 offen offset:2048 sc1
    buffer_load_dwordx4 v[120:123], v1, s[48:51], s63 offen offset:2048 sc1
    buffer_load_dwordx4 v[92:95], v1, s[48:51], s62 offen offset:3072 sc1
    buffer_load_dwordx4 v[124:127], v1, s[48:51], s63 offen offset:3072 sc1
    s_mov_b64 exec, 0xff
    buffer_load_dwordx2 v[12:13], v9, s[48:51], 0 offen offset:256 sc1
    s_mov_b64 exec, -1
    s_waitcnt vmcnt(16)
    v_mfma_f32_32x32x16_bf16 v[192:207], a[0:3], v[64:67], 0
    v_add_f32 v41, v41, v43
    v_add_f32 v45, v45, v47
    v_mov_b32 v42, v40
    s_waitcnt vmcnt(15)
    v_mfma_f32_32x32x16_bf16 v[208:223], a[32:35], v[96:99], 0
    v_add_f32 v41, v41, v45
    v_permlane32_swap_b32 v42, v40
    v_mov_b32 v43, v41
    v_max_f32 v44, v42, v40
    s_waitcnt vmcnt(14)
    v_mfma_f32_32x32x16_bf16 v[192:207], a[4:7], v[68:71], v[192:207]
    v_permlane32_swap_b32 v43, v41
    v_sub_f32 v56, v42, v44
    v_sub_f32 v57, v40, v44
    v_exp_f32 v56, v56
    s_waitcnt vmcnt(13)
    v_mfma_f32_32x32x16_bf16 v[208:223], a[36:39], v[100:103], v[208:223]
    v_exp_f32 v57, v57
    s_nop 0
    v_mul_f32 v45, v56, v43
    v_fmac_f32 v45, v57, v41
    s_waitcnt vmcnt(12)
    v_mfma_f32_32x32x16_bf16 v[192:207], a[8:11], v[72:75], v[192:207]
    ds_write_b64 v63, v[44:45] offset:0
    s_waitcnt vmcnt(11)
    v_mfma_f32_32x32x16_bf16 v[208:223], a[40:43], v[104:107], v[208:223]
    s_waitcnt vmcnt(10)
    v_mfma_f32_32x32x16_bf16 v[192:207], a[12:15], v[76:79], v[192:207]
    s_waitcnt vmcnt(9)
    v_mfma_f32_32x32x16_bf16 v[208:223], a[44:47], v[108:111], v[208:223]
    s_waitcnt vmcnt(8)
    v_mfma_f32_32x32x16_bf16 v[192:207], a[16:19], v[80:83], v[192:207]
    s_waitcnt vmcnt(7)
    v_mfma_f32_32x32x16_bf16 v[208:223], a[48:51], v[112:115], v[208:223]
    s_waitcnt vmcnt(6)
    v_mfma_f32_32x32x16_bf16 v[192:207], a[20:23], v[84:87], v[192:207]
    s_waitcnt vmcnt(5)
    v_mfma_f32_32x32x16_bf16 v[208:223], a[52:55], v[116:119], v[208:223]
    s_waitcnt vmcnt(4)
    v_mfma_f32_32x32x16_bf16 v[192:207], a[24:27], v[88:91], v[192:207]
    s_waitcnt vmcnt(3)
    v_mfma_f32_32x32x16_bf16 v[208:223], a[56:59], v[120:123], v[208:223]
    s_waitcnt vmcnt(2)
    v_mfma_f32_32x32x16_bf16 v[192:207], a[28:31], v[92:95], v[192:207]
    s_waitcnt vmcnt(1)
    v_mfma_f32_32x32x16_bf16 v[208:223], a[60:63], v[124:127], v[208:223]
    s_waitcnt vmcnt(0)
    s_mov_b64 exec, 0xff
    v_cmp_ne_u64 vcc, v[12:13], v[2:3]
    s_cbranch_vccz L_p1ok_59
    s_mov_b32 s88, 0
    s_mov_b64 exec, 0xff
L_spin_60:
    buffer_load_dwordx2 v[12:13], v9, s[48:51], 0 offen offset:256 sc1
    s_waitcnt vmcnt(0)
    v_cmp_ne_u64 vcc, v[12:13], v[2:3]
    s_cbranch_vccz L_spun_61
    s_add_u32 s88, s88, 1
    s_cmp_lt_u32 s88, 262144
    s_cbranch_scc1 L_spin_60
L_spun_61:
    s_mov_b64 exec, -1
L_p1ok_59:
    s_mov_b64 exec, -1
    v_mfma_f32_32x32x16_bf16 v[224:239], a[64:67], v[64:67], 0
    s_add_u32 s62, s61, 8192
    buffer_load_dwordx2 v[48:49], v8, s[48:51], s62 offen offset:0 sc1
    v_mfma_f32_32x32x16_bf16 v[240:255], a[96:99], v[96:99], 0
    buffer_load_dwordx2 v[50:51], v8, s[48:51], s62 offen offset:256 sc1
    v_mfma_f32_32x32x16_bf16 v[224:239], a[68:71], v[68:71], v[224:239]
    buffer_load_dwordx2 v[52:53], v8, s[48:51], s62 offen offset:512 sc1
    v_mfma_f32_32x32x16_bf16 v[240:255], a[100:103], v[100:103], v[240:255]
    buffer_load_dwordx2 v[54:55], v8, s[48:51], s62 offen offset:768 sc1
    v_mul_f32 v192, v56, v192
    v_mul_f32 v193, v56, v193
    v_mul_f32 v194, v56, v194
    v_mul_f32 v195, v56, v195
    v_mfma_f32_32x32x16_bf16 v[224:239], a[72:75], v[72:75], v[224:239]
    s_add_u32 s62, s60, 65536
    buffer_load_dwordx4 v[128:131], v1, s[48:51], s62 offen offset:0 sc1
    v_fmac_f32 v192, v57, v208
    v_fmac_f32 v193, v57, v209
    v_fmac_f32 v194, v57, v210
    v_fmac_f32 v195, v57, v211
    v_mfma_f32_32x32x16_bf16 v[240:255], a[104:107], v[104:107], v[240:255]
    s_add_u32 s63, s60, 73728
    buffer_load_dwordx4 v[160:163], v1, s[48:51], s63 offen offset:0 sc1
    ds_write_b128 v4, v[192:195] offset:0
    v_mul_f32 v196, v56, v196
    v_mul_f32 v197, v56, v197
    v_mul_f32 v198, v56, v198
    v_mfma_f32_32x32x16_bf16 v[224:239], a[76:79], v[76:79], v[224:239]
    buffer_load_dwordx4 v[132:135], v1, s[48:51], s62 offen offset:1024 sc1
    v_mul_f32 v199, v56, v199
    v_fmac_f32 v196, v57, v212
    v_fmac_f32 v197, v57, v213
    v_fmac_f32 v198, v57, v214
    v_mfma_f32_32x32x16_bf16 v[240:255], a[108:111], v[108:111], v[240:255]
    buffer_load_dwordx4 v[164:167], v1, s[48:51], s63 offen offset:1024 sc1
    v_fmac_f32 v199, v57, v215
    ds_write_b128 v5, v[196:199] offset:0
    v_mul_f32 v200, v56, v200
    v_mul_f32 v201, v56, v201
    v_mfma_f32_32x32x16_bf16 v[224:239], a[80:83], v[80:83], v[224:239]
    buffer_load_dwordx4 v[136:139], v1, s[48:51], s62 offen offset:2048 sc1
    v_mul_f32 v202, v56, v202
    v_mul_f32 v203, v56, v203
    v_fmac_f32 v200, v57, v216
    v_fmac_f32 v201, v57, v217
    v_mfma_f32_32x32x16_bf16 v[240:255], a[112:115], v[112:115], v[240:255]
    buffer_load_dwordx4 v[168:171], v1, s[48:51], s63 offen offset:2048 sc1
    v_fmac_f32 v202, v57, v218
    v_fmac_f32 v203, v57, v219
    ds_write_b128 v6, v[200:203] offset:0
    v_mul_f32 v204, v56, v204
    v_mfma_f32_32x32x16_bf16 v[224:239], a[84:87], v[84:87], v[224:239]
    buffer_load_dwordx4 v[140:143], v1, s[48:51], s62 offen offset:3072 sc1
    v_mul_f32 v205, v56, v205
    v_mul_f32 v206, v56, v206
    v_mul_f32 v207, v56, v207
    v_fmac_f32 v204, v57, v220
    v_mfma_f32_32x32x16_bf16 v[240:255], a[116:119], v[116:119], v[240:255]
    buffer_load_dwordx4 v[172:175], v1, s[48:51], s63 offen offset:3072 sc1
    v_fmac_f32 v205, v57, v221
    v_fmac_f32 v206, v57, v222
    v_fmac_f32 v207, v57, v223
    ds_write_b128 v7, v[204:207] offset:0
    v_mfma_f32_32x32x16_bf16 v[224:239], a[88:91], v[88:91], v[224:239]
    s_add_u32 s62, s60, 69632
    buffer_load_dwordx4 v[144:147], v1, s[48:51], s62 offen offset:0 sc1
    v_mfma_f32_32x32x16_bf16 v[240:255], a[120:123], v[120:123], v[240:255]
    s_add_u32 s63, s60, 77824
    buffer_load_dwordx4 v[176:179], v1, s[48:51], s63 offen offset:0 sc1
    v_mfma_f32_32x32x16_bf16 v[224:239], a[92:95], v[92:95], v[224:239]
    buffer_load_dwordx4 v[148:151], v1, s[48:51], s62 offen offset:1024 sc1
    v_mfma_f32_32x32x16_bf16 v[240:255], a[124:127], v[124:127], v[240:255]
    buffer_load_dwordx4 v[180:183], v1, s[48:51], s63 offen offset:1024 sc1
    v_mfma_f32_32x32x16_bf16 v[192:207], a[128:131], v[64:67], 0
    buffer_load_dwordx4 v[152:155], v1, s[48:51], s62 offen offset:2048 sc1
    v_mfma_f32_32x32x16_bf16 v[208:223], a[160:163], v[96:99], 0
    buffer_load_dwordx4 v[184:187], v1, s[48:51], s63 offen offset:2048 sc1
    v_mfma_f32_32x32x16_bf16 v[192:207], a[132:135], v[68:71], v[192:207]
    buffer_load_dwordx4 v[156:159], v1, s[48:51], s62 offen offset:3072 sc1
    v_mfma_f32_32x32x16_bf16 v[208:223], a[164:167], v[100:103], v[208:223]
    buffer_load_dwordx4 v[188:191], v1, s[48:51], s63 offen offset:3072 sc1
    s_nop 0
    v_mul_f32 v224, v56, v224
    v_mul_f32 v225, v56, v225
    v_mul_f32 v226, v56, v226
    v_mul_f32 v227, v56, v227
    v_mfma_f32_32x32x16_bf16 v[192:207], a[136:139], v[72:75], v[192:207]
    v_fmac_f32 v224, v57, v240
    v_fmac_f32 v225, v57, v241
    v_fmac_f32 v226, v57, v242
    v_fmac_f32 v227, v57, v243
    v_mfma_f32_32x32x16_bf16 v[208:223], a[168:171], v[104:107], v[208:223]
    ds_write_b128 v4, v[224:227] offset:4096
    v_mul_f32 v228, v56, v228
    v_mul_f32 v229, v56, v229
    v_mul_f32 v230, v56, v230
    v_mfma_f32_32x32x16_bf16 v[192:207], a[140:143], v[76:79], v[192:207]
    v_mul_f32 v231, v56, v231
    v_fmac_f32 v228, v57, v244
    v_fmac_f32 v229, v57, v245
    v_fmac_f32 v230, v57, v246
    v_mfma_f32_32x32x16_bf16 v[208:223], a[172:175], v[108:111], v[208:223]
    v_fmac_f32 v231, v57, v247
    ds_write_b128 v5, v[228:231] offset:4096
    v_mul_f32 v232, v56, v232
    v_mul_f32 v233, v56, v233
    v_mfma_f32_32x32x16_bf16 v[192:207], a[144:147], v[80:83], v[192:207]
    v_mul_f32 v234, v56, v234
    v_mul_f32 v235, v56, v235
    v_fmac_f32 v232, v57, v248
    v_fmac_f32 v233, v57, v249
    v_mfma_f32_32x32x16_bf16 v[208:223], a[176:179], v[112:115], v[208:223]
    v_fmac_f32 v234, v57, v250
    v_fmac_f32 v235, v57, v251
    ds_write_b128 v6, v[232:235] offset:4096
    v_mul_f32 v236, v56, v236
    v_mfma_f32_32x32x16_bf16 v[192:207], a[148:151], v[84:87], v[192:207]
    v_mul_f32 v237, v56, v237
    v_mul_f32 v238, v56, v238
    v_mul_f32 v239, v56, v239
    v_fmac_f32 v236, v57, v252
    v_mfma_f32_32x32x16_bf16 v[208:223], a[180:183], v[116:119], v[208:223]
    v_fmac_f32 v237, v57, v253
    v_fmac_f32 v238, v57, v254
    v_fmac_f32 v239, v57, v255
    ds_write_b128 v7, v[236:239] offset:4096
    v_mfma_f32_32x32x16_bf16 v[192:207], a[152:155], v[88:91], v[192:207]
    s_waitcnt vmcnt(16)
    v_add_f32 v49, v49, v51
    v_add_f32 v53, v53, v55
    v_mov_b32 v50, v48
    v_mfma_f32_32x32x16_bf16 v[208:223], a[184:187], v[120:123], v[208:223]
    v_add_f32 v49, v49, v53
    v_permlane32_swap_b32 v50, v48
    v_mov_b32 v51, v49
    v_max_f32 v52, v50, v48
    v_mfma_f32_32x32x16_bf16 v[192:207], a[156:159], v[92:95], v[192:207]
    v_permlane32_swap_b32 v51, v49
    v_sub_f32 v58, v50, v52
    v_sub_f32 v59, v48, v52
    v_exp_f32 v58, v58
    v_mfma_f32_32x32x16_bf16 v[208:223], a[188:191], v[124:127], v[208:223]
    v_exp_f32 v59, v59
    s_nop 0
    v_mul_f32 v53, v58, v51
    v_fmac_f32 v53, v59, v49
    ds_write_b64 v63, v[52:53] offset:1024
    s_waitcnt vmcnt(15)
    v_mfma_f32_32x32x16_bf16 v[224:239], a[0:3], v[128:131], 0
    s_waitcnt vmcnt(14)
    v_mfma_f32_32x32x16_bf16 v[240:255], a[32:35], v[160:163], 0
    s_waitcnt vmcnt(13)
    v_mfma_f32_32x32x16_bf16 v[224:239], a[4:7], v[132:135], v[224:239]
    s_waitcnt vmcnt(12)
    v_mfma_f32_32x32x16_bf16 v[240:255], a[36:39], v[164:167], v[240:255]
    v_mul_f32 v192, v56, v192
    v_mul_f32 v193, v56, v193
    v_mul_f32 v194, v56, v194
    v_mul_f32 v195, v56, v195
    v_fmac_f32 v192, v57, v208
    v_fmac_f32 v193, v57, v209
    s_waitcnt vmcnt(11)
    v_mfma_f32_32x32x16_bf16 v[224:239], a[8:11], v[136:139], v[224:239]
    v_fmac_f32 v194, v57, v210
    v_fmac_f32 v195, v57, v211
    ds_write_b128 v4, v[192:195] offset:8192
    v_mul_f32 v196, v56, v196
    v_mul_f32 v197, v56, v197
    v_mul_f32 v198, v56, v198
    s_waitcnt vmcnt(10)
    v_mfma_f32_32x32x16_bf16 v[240:255], a[40:43], v[168:171], v[240:255]
    v_mul_f32 v199, v56, v199
    v_fmac_f32 v196, v57, v212
    v_fmac_f32 v197, v57, v213
    v_fmac_f32 v198, v57, v214
    v_fmac_f32 v199, v57, v215
    ds_write_b128 v5, v[196:199] offset:8192
    s_waitcnt vmcnt(9)
    v_mfma_f32_32x32x16_bf16 v[224:239], a[12:15], v[140:143], v[224:239]
    v_mul_f32 v200, v56, v200
    v_mul_f32 v201, v56, v201
    v_mul_f32 v202, v56, v202
    v_mul_f32 v203, v56, v203
    v_fmac_f32 v200, v57, v216
    v_fmac_f32 v201, v57, v217
    s_waitcnt vmcnt(8)
    v_mfma_f32_32x32x16_bf16 v[240:255], a[44:47], v[172:175], v[240:255]
    v_fmac_f32 v202, v57, v218
    v_fmac_f32 v203, v57, v219
    ds_write_b128 v6, v[200:203] offset:8192
    v_mul_f32 v204, v56, v204
    v_mul_f32 v205, v56, v205
    v_mul_f32 v206, v56, v206
    s_waitcnt vmcnt(7)
    v_mfma_f32_32x32x16_bf16 v[224:239], a[16:19], v[144:147], v[224:239]
    v_mul_f32 v207, v56, v207
    v_fmac_f32 v204, v57, v220
    v_fmac_f32 v205, v57, v221
    v_fmac_f32 v206, v57, v222
    v_fmac_f32 v207, v57, v223
    ds_write_b128 v7, v[204:207] offset:8192
    s_waitcnt vmcnt(6)
    v_mfma_f32_32x32x16_bf16 v[240:255], a[48:51], v[176:179], v[240:255]
    s_waitcnt vmcnt(5)
    v_mfma_f32_32x32x16_bf16 v[224:239], a[20:23], v[148:151], v[224:239]
    s_waitcnt lgkmcnt(0)
    s_barrier
    ds_read_b128 v[64:67], v11 offset:0
    ds_read_b128 v[68:71], v11 offset:24576
    ds_read_b128 v[72:75], v15 offset:0
    ds_read_b128 v[76:79], v15 offset:24576
    ds_read_b128 v[96:99], v14 offset:0
    s_waitcnt vmcnt(4)
    v_mfma_f32_32x32x16_bf16 v[240:255], a[52:55], v[180:183], v[240:255]
    ds_read_b128 v[100:103], v14 offset:16
    s_waitcnt vmcnt(3)
    v_mfma_f32_32x32x16_bf16 v[224:239], a[24:27], v[152:155], v[224:239]
    s_waitcnt vmcnt(2)
    v_mfma_f32_32x32x16_bf16 v[240:255], a[56:59], v[184:187], v[240:255]
    s_waitcnt lgkmcnt(0)
    v_max3_f32 v44, v96, v98, v100
    v_max_f32 v44, v44, v102
    v_sub_f32 v40, v96, v44
    v_sub_f32 v41, v98, v44
    s_waitcnt vmcnt(1)
    v_mfma_f32_32x32x16_bf16 v[224:239], a[28:31], v[156:159], v[224:239]
    v_sub_f32 v42, v100, v44
    v_sub_f32 v43, v102, v44
    v_exp_f32 v40, v40
    v_exp_f32 v41, v41
    v_exp_f32 v42, v42
    v_exp_f32 v43, v43
    s_waitcnt vmcnt(0)
    v_mfma_f32_32x32x16_bf16 v[240:255], a[60:63], v[188:191], v[240:255]
    s_nop 0
    v_mul_f32 v45, v40, v97
    v_fmac_f32 v45, v41, v99
    v_fmac_f32 v45, v42, v101
    v_fmac_f32 v45, v43, v103
    v_rcp_f32 v45, v45
    v_mfma_f32_32x32x16_bf16 v[192:207], a[64:67], v[128:131], 0
    s_nop 0
    v_mul_f32 v40, v40, v45
    v_mul_f32 v41, v41, v45
    v_mul_f32 v42, v42, v45
    v_mul_f32 v43, v43, v45
    ds_read_b128 v[80:83], v11 offset:4096
    v_mfma_f32_32x32x16_bf16 v[208:223], a[96:99], v[160:163], 0
    ds_read_b128 v[84:87], v11 offset:28672
    ds_read_b128 v[88:91], v15 offset:4096
    ds_read_b128 v[92:95], v15 offset:28672
    v_mul_f32 v64, v40, v64
    v_mul_f32 v65, v40, v65
    v_mfma_f32_32x32x16_bf16 v[192:207], a[68:71], v[132:135], v[192:207]
    v_mul_f32 v66, v40, v66
    v_mul_f32 v67, v40, v67
    v_fmac_f32 v64, v41, v68
    v_fmac_f32 v65, v41, v69
    v_fmac_f32 v66, v41, v70
    v_fmac_f32 v67, v41, v71
    v_mfma_f32_32x32x16_bf16 v[208:223], a[100:103], v[164:167], v[208:223]
    v_mul_f32 v224, v58, v224
    v_mul_f32 v225, v58, v225
    v_mul_f32 v226, v58, v226
    v_mul_f32 v227, v58, v227
    v_fmac_f32 v224, v59, v240
    v_fmac_f32 v225, v59, v241
    v_mfma_f32_32x32x16_bf16 v[192:207], a[72:75], v[136:139], v[192:207]
    v_fmac_f32 v226, v59, v242
    v_fmac_f32 v227, v59, v243
    ds_write_b128 v4, v[224:227] offset:12288
    v_mul_f32 v228, v58, v228
    v_mul_f32 v229, v58, v229
    v_mul_f32 v230, v58, v230
    v_mfma_f32_32x32x16_bf16 v[208:223], a[104:107], v[168:171], v[208:223]
    v_mul_f32 v231, v58, v231
    v_fmac_f32 v228, v59, v244
    v_fmac_f32 v229, v59, v245
    v_fmac_f32 v230, v59, v246
    v_fmac_f32 v231, v59, v247
    ds_write_b128 v5, v[228:231] offset:12288
    v_mfma_f32_32x32x16_bf16 v[192:207], a[76:79], v[140:143], v[192:207]
    v_mul_f32 v232, v58, v232
    v_mul_f32 v233, v58, v233
    v_mul_f32 v234, v58, v234
    v_mul_f32 v235, v58, v235
    v_fmac_f32 v232, v59, v248
    v_fmac_f32 v233, v59, v249
    v_mfma_f32_32x32x16_bf16 v[208:223], a[108:111], v[172:175], v[208:223]
    v_fmac_f32 v234, v59, v250
    v_fmac_f32 v235, v59, v251
    ds_write_b128 v6, v[232:235] offset:12288
    v_mul_f32 v236, v58, v236
    v_mul_f32 v237, v58, v237
    v_mul_f32 v238, v58, v238
    v_mfma_f32_32x32x16_bf16 v[192:207], a[80:83], v[144:147], v[192:207]
    v_mul_f32 v239, v58, v239
    v_fmac_f32 v236, v59, v252
    v_fmac_f32 v237, v59, v253
    v_fmac_f32 v238, v59, v254
    v_fmac_f32 v239, v59, v255
    ds_write_b128 v7, v[236:239] offset:12288
    v_mfma_f32_32x32x16_bf16 v[208:223], a[112:115], v[176:179], v[208:223]
    v_fmac_f32 v64, v42, v72
    v_fmac_f32 v65, v42, v73
    v_fmac_f32 v66, v42, v74
    v_fmac_f32 v67, v42, v75
    v_fmac_f32 v64, v43, v76
    v_fmac_f32 v65, v43, v77
    v_mfma_f32_32x32x16_bf16 v[192:207], a[84:87], v[148:151], v[192:207]
    v_fmac_f32 v66, v43, v78
    v_fmac_f32 v67, v43, v79
    v_lshlrev_b32 v68, 16, v28
    v_and_b32 v69, s91, v28
    v_lshlrev_b32 v70, 16, v29
    v_and_b32 v71, s91, v29
    v_mfma_f32_32x32x16_bf16 v[208:223], a[116:119], v[180:183], v[208:223]
    v_fmac_f32 v68, v16, v64
    v_fmac_f32 v69, v17, v65
    v_fmac_f32 v70, v18, v66
    v_fmac_f32 v71, v19, v67
    v_cvt_pk_bf16_f32 v28, v68, v69
    v_cvt_pk_bf16_f32 v29, v70, v71
    v_mfma_f32_32x32x16_bf16 v[192:207], a[88:91], v[152:155], v[192:207]
    s_add_u32 s56, s69, 0
    buffer_store_dwordx2 v[28:29], v10, s[40:43], s56 offen offset:0
    ds_read_b128 v[64:67], v11 offset:8192
    ds_read_b128 v[68:71], v11 offset:32768
    ds_read_b128 v[72:75], v15 offset:8192
    ds_read_b128 v[76:79], v15 offset:32768
    s_waitcnt lgkmcnt(8)
    v_mfma_f32_32x32x16_bf16 v[208:223], a[120:123], v[184:187], v[208:223]
    v_mul_f32 v80, v40, v80
    v_mul_f32 v81, v40, v81
    v_mul_f32 v82, v40, v82
    v_mul_f32 v83, v40, v83
    v_fmac_f32 v80, v41, v84
    v_fmac_f32 v81, v41, v85
    v_mfma_f32_32x32x16_bf16 v[192:207], a[92:95], v[156:159], v[192:207]
    v_fmac_f32 v82, v41, v86
    v_fmac_f32 v83, v41, v87
    v_fmac_f32 v80, v42, v88
    v_fmac_f32 v81, v42, v89
    v_fmac_f32 v82, v42, v90
    v_fmac_f32 v83, v42, v91
    v_mfma_f32_32x32x16_bf16 v[208:223], a[124:127], v[188:191], v[208:223]
    v_fmac_f32 v80, v43, v92
    v_fmac_f32 v81, v43, v93
    v_fmac_f32 v82, v43, v94
    v_fmac_f32 v83, v43, v95
    v_lshlrev_b32 v84, 16, v30
    v_and_b32 v85, s91, v30
    v_mfma_f32_32x32x16_bf16 v[224:239], a[128:131], v[128:131], 0
    v_lshlrev_b32 v86, 16, v31
    v_and_b32 v87, s91, v31
    v_fmac_f32 v84, v20, v80
    v_fmac_f32 v85, v21, v81
    v_fmac_f32 v86, v22, v82
    v_fmac_f32 v87, v23, v83
    v_mfma_f32_32x32x16_bf16 v[240:255], a[160:163], v[160:163], 0
    v_cvt_pk_bf16_f32 v30, v84, v85
    v_cvt_pk_bf16_f32 v31, v86, v87
    buffer_store_dwordx2 v[30:31], v10, s[40:43], s56 offen offset:64
    s_waitcnt lgkmcnt(0)
    v_mul_f32 v64, v40, v64
    v_mul_f32 v65, v40, v65
    v_mfma_f32_32x32x16_bf16 v[224:239], a[132:135], v[132:135], v[224:239]
    v_mul_f32 v66, v40, v66
    v_mul_f32 v67, v40, v67
    v_fmac_f32 v64, v41, v68
    v_fmac_f32 v65, v41, v69
    v_fmac_f32 v66, v41, v70
    v_fmac_f32 v67, v41, v71
    v_mfma_f32_32x32x16_bf16 v[240:255], a[164:167], v[164:167], v[240:255]
    v_mul_f32 v192, v58, v192
    v_mul_f32 v193, v58, v193
    v_mul_f32 v194, v58, v194
    v_mul_f32 v195, v58, v195
    v_fmac_f32 v192, v59, v208
    v_fmac_f32 v193, v59, v209
    v_mfma_f32_32x32x16_bf16 v[224:239], a[136:139], v[136:139], v[224:239]
    v_fmac_f32 v194, v59, v210
    v_fmac_f32 v195, v59, v211
    ds_write_b128 v4, v[192:195] offset:16384
    v_mul_f32 v196, v58, v196
    v_mul_f32 v197, v58, v197
    v_mul_f32 v198, v58, v198
    v_mfma_f32_32x32x16_bf16 v[240:255], a[168:171], v[168:171], v[240:255]
    v_mul_f32 v199, v58, v199
    v_fmac_f32 v196, v59, v212
    v_fmac_f32 v197, v59, v213
    v_fmac_f32 v198, v59, v214
    v_fmac_f32 v199, v59, v215
    ds_write_b128 v5, v[196:199] offset:16384
    v_mfma_f32_32x32x16_bf16 v[224:239], a[140:143], v[140:143], v[224:239]
    v_mul_f32 v200, v58, v200
    v_mul_f32 v201, v58, v201
    v_mul_f32 v202, v58, v202
    v_mul_f32 v203, v58, v203
    v_fmac_f32 v200, v59, v216
    v_fmac_f32 v201, v59, v217
    v_mfma_f32_32x32x16_bf16 v[240:255], a[172:175], v[172:175], v[240:255]
    v_fmac_f32 v202, v59, v218
    v_fmac_f32 v203, v59, v219
    ds_write_b128 v6, v[200:203] offset:16384
    v_mul_f32 v204, v58, v204
    v_mul_f32 v205, v58, v205
    v_mul_f32 v206, v58, v206
    v_mfma_f32_32x32x16_bf16 v[224:239], a[144:147], v[144:147], v[224:239]
    v_mul_f32 v207, v58, v207
    v_fmac_f32 v204, v59, v220
    v_fmac_f32 v205, v59, v221
    v_fmac_f32 v206, v59, v222
    v_fmac_f32 v207, v59, v223
    ds_write_b128 v7, v[204:207] offset:16384
    v_mfma_f32_32x32x16_bf16 v[240:255], a[176:179], v[176:179], v[240:255]
    v_fmac_f32 v64, v42, v72
    v_fmac_f32 v65, v42, v73
    v_fmac_f32 v66, v42, v74
    v_fmac_f32 v67, v42, v75
    v_fmac_f32 v64, v43, v76
    v_fmac_f32 v65, v43, v77
    v_mfma_f32_32x32x16_bf16 v[224:239], a[148:151], v[148:151], v[224:239]
    v_fmac_f32 v66, v43, v78
    v_fmac_f32 v67, v43, v79
    v_lshlrev_b32 v68, 16, v32
    v_and_b32 v69, s91, v32
    v_lshlrev_b32 v70, 16, v33
    v_and_b32 v71, s91, v33
    v_mfma_f32_32x32x16_bf16 v[240:255], a[180:183], v[180:183], v[240:255]
    v_fmac_f32 v68, v24, v64
    v_fmac_f32 v69, v25, v65
    v_fmac_f32 v70, v26, v66
    v_fmac_f32 v71, v27, v67
    v_cvt_pk_bf16_f32 v32, v68, v69
    v_cvt_pk_bf16_f32 v33, v70, v71
    v_mfma_f32_32x32x16_bf16 v[224:239], a[152:155], v[152:155], v[224:239]
    buffer_store_dwordx2 v[32:33], v10, s[40:43], s56 offen offset:128
    ds_read_b128 v[96:99], v14 offset:1024
    ds_read_b128 v[100:103], v14 offset:1040
    v_mfma_f32_32x32x16_bf16 v[240:255], a[184:187], v[184:187], v[240:255]
    v_mfma_f32_32x32x16_bf16 v[224:239], a[156:159], v[156:159], v[224:239]
    s_waitcnt lgkmcnt(0)
    v_max3_f32 v52, v96, v98, v100
    v_max_f32 v52, v52, v102
    v_mfma_f32_32x32x16_bf16 v[240:255], a[188:191], v[188:191], v[240:255]
    v_sub_f32 v48, v96, v52
    v_sub_f32 v49, v98, v52
    v_sub_f32 v50, v100, v52
    v_sub_f32 v51, v102, v52
    v_exp_f32 v48, v48
    v_exp_f32 v49, v49
    v_exp_f32 v50, v50
    v_exp_f32 v51, v51
    s_nop 0
    v_mul_f32 v53, v48, v97
    v_fmac_f32 v53, v49, v99
    v_fmac_f32 v53, v50, v101
    v_fmac_f32 v53, v51, v103
    v_rcp_f32 v53, v53
    s_nop 0
    v_mul_f32 v48, v48, v53
    v_mul_f32 v49, v49, v53
    v_mul_f32 v50, v50, v53
    v_mul_f32 v51, v51, v53
    v_pk_mul_f32 v[224:225], v[58:59], v[224:225] op_sel_hi:[0,1]
    v_pk_mul_f32 v[226:227], v[58:59], v[226:227] op_sel_hi:[0,1]
    v_pk_fma_f32 v[224:225], v[58:59], v[240:241], v[224:225] op_sel:[1,0,0] op_sel_hi:[1,1,1]
    v_pk_fma_f32 v[226:227], v[58:59], v[242:243], v[226:227] op_sel:[1,0,0] op_sel_hi:[1,1,1]
    ds_write_b128 v4, v[224:227] offset:20480
    v_pk_mul_f32 v[228:229], v[58:59], v[228:229] op_sel_hi:[0,1]
    v_pk_mul_f32 v[230:231], v[58:59], v[230:231] op_sel_hi:[0,1]
    v_pk_fma_f32 v[228:229], v[58:59], v[244:245], v[228:229] op_sel:[1,0,0] op_sel_hi:[1,1,1]
    v_pk_fma_f32 v[230:231], v[58:59], v[246:247], v[230:231] op_sel:[1,0,0] op_sel_hi:[1,1,1]
    ds_write_b128 v5, v[228:231] offset:20480
    v_pk_mul_f32 v[232:233], v[58:59], v[232:233] op_sel_hi:[0,1]
    v_pk_mul_f32 v[234:235], v[58:59], v[234:235] op_sel_hi:[0,1]
    v_pk_fma_f32 v[232:233], v[58:59], v[248:249], v[232:233] op_sel:[1,0,0] op_sel_hi:[1,1,1]
    v_pk_fma_f32 v[234:235], v[58:59], v[250:251], v[234:235] op_sel:[1,0,0] op_sel_hi:[1,1,1]
    ds_write_b128 v6, v[232:235] offset:20480
    v_pk_mul_f32 v[236:237], v[58:59], v[236:237] op_sel_hi:[0,1]
    v_pk_mul_f32 v[238:239], v[58:59], v[238:239] op_sel_hi:[0,1]
    v_pk_fma_f32 v[236:237], v[58:59], v[252:253], v[236:237] op_sel:[1,0,0] op_sel_hi:[1,1,1]
    v_pk_fma_f32 v[238:239], v[58:59], v[254:255], v[238:239] op_sel:[1,0,0] op_sel_hi:[1,1,1]
    ds_write_b128 v7, v[236:239] offset:20480
    s_waitcnt lgkmcnt(0)
    s_barrier
    ds_read_b128 v[64:67], v11 offset:12288
    ds_read_b128 v[68:71], v11 offset:36864
    ds_read_b128 v[72:75], v15 offset:12288
    ds_read_b128 v[76:79], v15 offset:36864
    ds_read_b128 v[80:83], v11 offset:16384
    ds_read_b128 v[84:87], v11 offset:40960
    ds_read_b128 v[88:91], v15 offset:16384
    ds_read_b128 v[92:95], v15 offset:40960
    s_waitcnt lgkmcnt(4)
    v_pk_mul_f32 v[64:65], v[48:49], v[64:65] op_sel_hi:[0,1]
    v_pk_mul_f32 v[66:67], v[48:49], v[66:67] op_sel_hi:[0,1]
    v_pk_fma_f32 v[64:65], v[48:49], v[68:69], v[64:65] op_sel:[1,0,0] op_sel_hi:[1,1,1]
    v_pk_fma_f32 v[66:67], v[48:49], v[70:71], v[66:67] op_sel:[1,0,0] op_sel_hi:[1,1,1]
    v_pk_fma_f32 v[64:65], v[50:51], v[72:73], v[64:65] op_sel_hi:[0,1,1]
    v_pk_fma_f32 v[66:67], v[50:51], v[74:75], v[66:67] op_sel_hi:[0,1,1]
    v_pk_fma_f32 v[64:65], v[50:51], v[76:77], v[64:65] op_sel:[1,0,0] op_sel_hi:[1,1,1]
    v_pk_fma_f32 v[66:67], v[50:51], v[78:79], v[66:67] op_sel:[1,0,0] op_sel_hi:[1,1,1]
    v_lshlrev_b32 v68, 16, v34
    v_and_b32 v69, s91, v34
    v_lshlrev_b32 v70, 16, v35
    v_and_b32 v71, s91, v35
    v_pk_fma_f32 v[68:69], v[16:17], v[64:65], v[68:69]
    v_pk_fma_f32 v[70:71], v[18:19], v[66:67], v[70:71]
    v_cvt_pk_bf16_f32 v34, v68, v69
    v_cvt_pk_bf16_f32 v35, v70, v71
    s_add_u32 s56, s69, 49152
    buffer_store_dwordx2 v[34:35], v10, s[40:43], s56 offen offset:0
    ds_read_b128 v[64:67], v11 offset:20480
    ds_read_b128 v[68:71], v11 offset:45056
    ds_read_b128 v[72:75], v15 offset:20480
    ds_read_b128 v[76:79], v15 offset:45056
    s_waitcnt lgkmcnt(4)
    v_pk_mul_f32 v[80:81], v[48:49], v[80:81] op_sel_hi:[0,1]
    v_pk_mul_f32 v[82:83], v[48:49], v[82:83] op_sel_hi:[0,1]
    v_pk_fma_f32 v[80:81], v[48:49], v[84:85], v[80:81] op_sel:[1,0,0] op_sel_hi:[1,1,1]
    v_pk_fma_f32 v[82:83], v[48:49], v[86:87], v[82:83] op_sel:[1,0,0] op_sel_hi:[1,1,1]
    v_pk_fma_f32 v[80:81], v[50:51], v[88:89], v[80:81] op_sel_hi:[0,1,1]
    v_pk_fma_f32 v[82:83], v[50:51], v[90:91], v[82:83] op_sel_hi:[0,1,1]
    v_pk_fma_f32 v[80:81], v[50:51], v[92:93], v[80:81] op_sel:[1,0,0] op_sel_hi:[1,1,1]
    v_pk_fma_f32 v[82:83], v[50:51], v[94:95], v[82:83] op_sel:[1,0,0] op_sel_hi:[1,1,1]
    v_lshlrev_b32 v84, 16, v36
    v_and_b32 v85, s91, v36
    v_lshlrev_b32 v86, 16, v37
    v_and_b32 v87, s91, v37
    v_pk_fma_f32 v[84:85], v[20:21], v[80:81], v[84:85]
    v_pk_fma_f32 v[86:87], v[22:23], v[82:83], v[86:87]
    v_cvt_pk_bf16_f32 v36, v84, v85
    v_cvt_pk_bf16_f32 v37, v86, v87
    buffer_store_dwordx2 v[36:37], v10, s[40:43], s56 offen offset:64
    s_waitcnt lgkmcnt(0)
    v_pk_mul_f32 v[64:65], v[48:49], v[64:65] op_sel_hi:[0,1]
    v_pk_mul_f32 v[66:67], v[48:49], v[66:67] op_sel_hi:[0,1]
    v_pk_fma_f32 v[64:65], v[48:49], v[68:69], v[64:65] op_sel:[1,0,0] op_sel_hi:[1,1,1]
    v_pk_fma_f32 v[66:67], v[48:49], v[70:71], v[66:67] op_sel:[1,0,0] op_sel_hi:[1,1,1]
    v_pk_fma_f32 v[64:65], v[50:51], v[72:73], v[64:65] op_sel_hi:[0,1,1]
    v_pk_fma_f32 v[66:67], v[50:51], v[74:75], v[66:67] op_sel_hi:[0,1,1]
    v_pk_fma_f32 v[64:65], v[50:51], v[76:77], v[64:65] op_sel:[1,0,0] op_sel_hi:[1,1,1]
    v_pk_fma_f32 v[66:67], v[50:51], v[78:79], v[66:67] op_sel:[1,0,0] op_sel_hi:[1,1,1]
    v_lshlrev_b32 v68, 16, v38
    v_and_b32 v69, s91, v38
    v_lshlrev_b32 v70, 16, v39
    v_and_b32 v71, s91, v39
    v_pk_fma_f32 v[68:69], v[24:25], v[64:65], v[68:69]
    v_pk_fma_f32 v[70:71], v[26:27], v[66:67], v[70:71]
    v_cvt_pk_bf16_f32 v38, v68, v69
    v_cvt_pk_bf16_f32 v39, v70, v71
    buffer_store_dwordx2 v[38:39], v10, s[40:43], s56 offen offset:128
L_fin:
    s_waitcnt vmcnt(0)
L_end:
    s_endpgm
L_codeend:
.section .rodata,"a"
.p2align 6
.amdhsa_kernel standalone__dit_adaln_block__diffusion_kernel
  .amdhsa_next_free_vgpr 512
  .amdhsa_next_free_sgpr 102
  .amdhsa_accum_offset 256
  .amdhsa_group_segment_fixed_size 0
  .amdhsa_kernarg_size 64
  .amdhsa_user_sgpr_count 2
  .amdhsa_user_sgpr_kernarg_segment_ptr 1
  .amdhsa_system_sgpr_workgroup_id_x 1
  .amdhsa_float_denorm_mode_32 3
.end_amdhsa_kernel
```
